```python
import torch

def _softmax(x, axis=-1):
    return torch.softmax(x, dim=axis)
def _gelu(x):
    return torch.nn.functional.gelu(x, approximate="tanh")
def _silu(x):
    return torch.nn.functional.silu(x)
def _sigmoid(x):
    return torch.sigmoid(x)
def _layernorm(x, axis=-1, eps=1e-5):
    m = x.mean(dim=axis, keepdim=True)
    v = x.var(dim=axis, keepdim=True, unbiased=False)
    return (x - m) / torch.sqrt(v + eps)
def _scatter_add(tgt, idx, src, axis=0):
    return tgt.clone().index_add_(axis, idx, src)
def _segment_sum(src, seg, n):
    out = torch.zeros((n,) + src.shape[1:], dtype=src.dtype)
    return out.index_add_(0, seg, src)
def _pad(x, pw):
    flat = tuple(v for pair in reversed(pw) for v in pair)
    return torch.nn.functional.pad(x, flat)

kernel_name = 'parallel_sum__sliding_block_cached__dense_activation_silu__decode'

def setup_inputs():

    _w = (lambda a: (lambda t: t.to(torch.bfloat16) if t.is_floating_point() else t)(torch.as_tensor(a)))
    def _A_setup():
        B, Sq, D = 1, 1, 1024
        Hq, Hkv, Sk, Dh = 32, 4, 65536, 128
        assert Hq % Hkv == 0, (Hq, Hkv)
        return {
            "x": _w((lambda *s: torch.randn(*s, dtype=torch.bfloat16) * 0.05)(B, Sq, D)),
            "k_cache": _w((lambda *s: torch.randn(*s, dtype=torch.bfloat16) * 3.2)(B, Hkv, Sk, Dh)),
            "v_cache": _w((lambda *s: torch.randn(*s, dtype=torch.bfloat16) * 0.8)(B, Hkv, Sk, Dh)),
            "wq": _w((lambda *s: torch.randn(*s, dtype=torch.bfloat16) * 3.2)(D, Hq * Dh) * (D ** -0.5)),
            "wo": _w((lambda *s: torch.randn(*s, dtype=torch.bfloat16) * 0.8)(Hq * Dh, D) * ((Hq * Dh) ** -0.5)),
        }
    _A_in = _A_setup()

    def _B_setup():
        B, S, D, F = 1, 1, 1024, 3584
        return {
            "x": _w((lambda *s: torch.randn(*s, dtype=torch.bfloat16) * 0.05)(B, S, D)),
            "w1": _w((lambda *s: torch.randn(*s, dtype=torch.bfloat16) * 3.2)(D, F) * (D ** -0.5)),
            "w2": _w((lambda *s: torch.randn(*s, dtype=torch.bfloat16) * 0.2)(F, D) * (F ** -0.5)),
        }
    _B_in = _B_setup()

    return {
        "A_x": _A_in["x"],
        "A_k_cache": _A_in["k_cache"],
        "A_v_cache": _A_in["v_cache"],
        "A_wq": _A_in["wq"],
        "A_wo": _A_in["wo"],
        "B_x": _B_in["x"],
        "B_w1": _B_in["w1"],
        "B_w2": _B_in["w2"],
    }

def reference(A_x, A_k_cache, A_v_cache, A_wq, A_wo, B_x, B_w1, B_w2):
    def _A_ref(x, k_cache, v_cache, wq, wo):
        B, Sq, D = x.shape
        Hq, Dh = 32, 128
        Hkv, Sk = k_cache.shape[1], k_cache.shape[2]
        W = min(4096, max(256, Sk // 4))
        rep = Hq // Hkv
        q = (lambda x, *d: x.permute(*d))((x @ wq).reshape(B, Sq, Hq, Dh), 0, 2, 1, 3)
        k = (lambda x, n, axis: torch.repeat_interleave(x, n, dim=axis))(k_cache[:, :, Sk - W:, :], rep, axis=1)
        v = (lambda x, n, axis: torch.repeat_interleave(x, n, dim=axis))(v_cache[:, :, Sk - W:, :], rep, axis=1)
        scores = torch.einsum("bhqd,bhkd->bhqk", q, k) * (Dh ** -0.5)
        p = _softmax(scores, axis=-1)
        o = torch.einsum("bhqk,bhkd->bhqd", p, v)
        return (lambda x, *d: x.permute(*d))(o, 0, 2, 1, 3).reshape(B, Sq, Hq * Dh) @ wo

    def _B_ref(x, w1, w2):
        h = torch.einsum("bsd,df->bsf", x, w1)
        h = _silu(h)
        out = torch.einsum("bsf,fd->bsd", h, w2)
        return out

    x = A_x
    xn = _layernorm(x, axis=-1)
    return x + _A_ref(xn, A_k_cache, A_v_cache, A_wq, A_wo) + _B_ref(xn, B_w1, B_w2)
```

```asm
; @launch grid=(256,1,1) block=(576,1,1) lds=163840
.amdgcn_target "amdgcn-amd-amdhsa--gfx950"
.text
.globl parallel_sum__sliding_block_cached__dense_activation_silu__decode_kernel
.p2align 8
.type parallel_sum__sliding_block_cached__dense_activation_silu__decode_kernel,@function
parallel_sum__sliding_block_cached__dense_activation_silu__decode_kernel:
    s_load_dwordx2 s[32:33], s[0:1], 24
    s_load_dwordx2 s[40:41], s[0:1], 0
    v_cmp_gt_u32 vcc, 64, v0
    s_load_dwordx16 s[8:23], s[0:1], 0
    s_load_dwordx2 s[24:25], s[0:1], 64
    s_load_dwordx2 s[28:29], s[0:1], 80
    s_cmp_ge_u32 s2, 256
    s_nop 0
    s_cbranch_scc1 Lend
    s_and_b32 s4, s2, 3
    s_mov_b32 s35, 0x20000
    s_cbranch_vccnz Lld
    v_lshrrev_b32 v1, 6, v0
    v_and_b32 v0, 63, v0
    s_movk_i32 s42, 2048
    v_readfirstlane_b32 s3, v1
    s_mov_b32 s43, s35
    s_lshl_b32 s44, s4, 9
    v_lshlrev_b32 v5, 5, v0
    v_lshl_add_u32 v6, v0, 3, s44
    s_cmp_eq_u32 s3, 1
    s_nop 0
    s_cbranch_scc0 Lnox
    s_waitcnt lgkmcnt(0)
    buffer_load_dwordx4 v[12:15], v5, s[40:43], 0 offen
    buffer_load_dwordx4 v[16:19], v5, s[40:43], 0 offen offset:16
    buffer_load_dwordx2 v[20:21], v6, s[40:43], 0 offen
    s_branch Lnox
Lld:
    v_lshrrev_b32 v1, 3, v0
    v_and_b32 v2, 6, v1
    v_and_b32 v3, 7, v0
    v_xor_b32 v2, v2, v3
    v_lshlrev_b32 v2, 4, v2
    v_lshl_add_u32 v3, v1, 13, v2
    s_lshr_b32 s5, s2, 2
    s_lshl_b32 s30, s5, 7
    s_lshl_b32 s60, s4, 21
    s_add_u32 s60, s60, s30
    s_lshl_b32 s34, s35, 6
    s_lshr_b32 s97, s35, 1
    s_movk_i32 s96, 1024
    s_movk_i32 m0, 28672
    s_movk_i32 s58, 3
    v_mov_b32 v8, 159744
    v_mov_b32 v12, 0
    v_lshl_add_u32 v9, v0, 2, v8
    ds_write_b32 v9, v12
    s_waitcnt lgkmcnt(0)
Ll0:
    buffer_load_dwordx4 v3, s[32:35], s60 offen nt lds
    s_add_u32 m0, m0, s96
    s_add_u32 s60, s60, s97
    buffer_load_dwordx4 v3, s[32:35], s60 offen nt lds
    s_add_u32 m0, m0, s96
    s_add_u32 s60, s60, s97
    buffer_load_dwordx4 v3, s[32:35], s60 offen nt lds
    s_add_u32 m0, m0, s96
    s_add_u32 s60, s60, s97
    buffer_load_dwordx4 v3, s[32:35], s60 offen nt lds
    s_add_u32 m0, m0, s96
    s_add_u32 s60, s60, s97
    s_sub_u32 s58, s58, 1
    s_cbranch_scc0 Ll0
    s_barrier
Lload:
    s_mul_i32 s62, s4, 1835008
    s_add_u32 s62, s62, s30
    s_mov_b32 s3, 0
    s_bfe_u32 s6, s2, 0x20001
    s_lshr_b32 s7, s2, 3
    s_lshl_b32 s7, s7, 1
    s_and_b32 s30, s2, 1
    s_add_u32 s7, s7, s30
    s_lshr_b32 s26, s2, 5
    s_lshl_b32 s26, s26, 3
    s_and_b32 s30, s2, 7
    s_add_u32 s26, s26, s30
    s_bfe_u32 s27, s2, 0x20003
    s_movk_i32 s30, 7168
    v_lshl_add_u32 v4, v1, 8, v2
    v_mad_u32_u24 v5, v1, s30, v2
    v_lshl_add_u32 v6, v1, 11, v2
    s_lshl_b32 s61, s6, 24
    s_lshl_b32 s30, s7, 14
    s_add_u32 s61, s61, s30
    s_add_u32 s61, s61, 15728640
    s_lshl_b32 s30, s27, 9
    s_mul_i32 s63, s26, 114688
    s_add_u32 s63, s63, s30
    s_lshl_b32 s31, s26, 17
    s_add_u32 s31, s31, s30
    s_movk_i32 s98, 1920
    s_mov_b32 s99, 57344
    s_movk_i32 s100, 16000
    s_movk_i32 s101, 128
    s_mov_b32 s36, s10
    s_and_b32 s37, s11, 0xffff
    s_mov_b32 s38, 67108864
    s_mov_b32 s39, 0x20000
    s_mov_b32 s40, s12
    s_and_b32 s41, s13, 0xffff
    s_mov_b32 s42, 67108864
    s_mov_b32 s43, 0x20000
    s_mov_b32 s44, s20
    s_and_b32 s45, s21, 0xffff
    s_mov_b32 s46, 7340032
    s_mov_b32 s47, 0x20000
    s_mov_b32 s48, s22
    s_and_b32 s49, s23, 0xffff
    s_mov_b32 s50, 7340032
    s_mov_b32 s51, 0x20000
    s_mov_b32 s52, s16
    s_and_b32 s53, s17, 0xffff
    s_mov_b32 s54, 8388608
    s_mov_b32 s55, 0x20000
    s_mov_b32 s59, s61
    s_cmp_ge_u32 s2, 224
    s_cselect_b32 s46, 0, s46
    buffer_load_dwordx4 v3, s[32:35], s60 offen nt lds
    s_add_u32 m0, m0, s96
    s_add_u32 s60, s60, s97
    s_waitcnt vmcnt(16)
    buffer_load_dwordx4 v3, s[32:35], s60 offen nt lds
    s_add_u32 m0, m0, s96
    s_add_u32 s60, s60, s97
    s_waitcnt vmcnt(16)
    buffer_load_dwordx4 v3, s[32:35], s60 offen nt lds
    s_add_u32 m0, m0, s96
    s_add_u32 s60, s60, s97
    s_waitcnt vmcnt(16)
    buffer_load_dwordx4 v3, s[32:35], s60 offen nt lds
    s_add_u32 m0, m0, s96
    s_add_u32 s60, s60, s97
    s_waitcnt vmcnt(16)
    buffer_load_dwordx4 v3, s[32:35], s60 offen nt lds
    s_add_u32 m0, m0, s96
    s_add_u32 s60, s60, s97
    s_waitcnt vmcnt(16)
    buffer_load_dwordx4 v3, s[32:35], s60 offen nt lds
    s_add_u32 m0, m0, s96
    s_add_u32 s60, s60, s97
    s_waitcnt vmcnt(16)
    buffer_load_dwordx4 v3, s[32:35], s60 offen nt lds
    s_add_u32 m0, m0, s96
    s_add_u32 s60, s60, s97
    s_waitcnt vmcnt(16)
    buffer_load_dwordx4 v3, s[32:35], s60 offen nt lds
    s_add_u32 m0, m0, s96
    s_add_u32 s60, s60, s97
    s_waitcnt vmcnt(16)
    buffer_load_dwordx4 v3, s[32:35], s60 offen nt lds
    s_add_u32 m0, m0, s96
    s_add_u32 s60, s60, s97
    s_waitcnt vmcnt(16)
    buffer_load_dwordx4 v3, s[32:35], s60 offen nt lds
    s_add_u32 m0, m0, s96
    s_add_u32 s60, s60, s97
    s_waitcnt vmcnt(16)
    buffer_load_dwordx4 v3, s[32:35], s60 offen nt lds
    s_add_u32 m0, m0, s96
    s_add_u32 s60, s60, s97
    s_waitcnt vmcnt(16)
    buffer_load_dwordx4 v3, s[32:35], s60 offen nt lds
    s_add_u32 m0, m0, s96
    s_add_u32 s60, s60, s97
    s_waitcnt vmcnt(16)
    buffer_load_dwordx4 v3, s[32:35], s60 offen nt lds
    s_add_u32 m0, m0, s96
    s_add_u32 s60, s60, s97
    s_waitcnt vmcnt(16)
    buffer_load_dwordx4 v3, s[32:35], s60 offen nt lds
    s_add_u32 m0, m0, s96
    s_add_u32 s60, s60, s97
    s_waitcnt vmcnt(16)
    buffer_load_dwordx4 v3, s[32:35], s60 offen nt lds
    s_add_u32 m0, m0, s96
    s_add_u32 s60, s60, s97
    s_waitcnt vmcnt(16)
    buffer_load_dwordx4 v3, s[32:35], s60 offen nt lds
    s_waitcnt vmcnt(16)
    s_mov_b32 m0, 61440
    s_nop 0
    buffer_load_dwordx4 v4, s[36:39], s59 offen nt lds
    s_add_u32 m0, m0, s96
    s_add_u32 s59, s59, s101
    s_waitcnt vmcnt(16)
    buffer_load_dwordx4 v4, s[36:39], s59 offen nt lds
    s_add_u32 m0, m0, s96
    s_add_u32 s59, s59, s98
    s_waitcnt vmcnt(16)
    buffer_load_dwordx4 v4, s[36:39], s59 offen nt lds
    s_add_u32 m0, m0, s96
    s_add_u32 s59, s59, s101
    s_waitcnt vmcnt(16)
    buffer_load_dwordx4 v4, s[36:39], s59 offen nt lds
    s_add_u32 m0, m0, s96
    s_add_u32 s59, s59, s98
    s_waitcnt vmcnt(16)
    buffer_load_dwordx4 v4, s[36:39], s59 offen nt lds
    s_add_u32 m0, m0, s96
    s_add_u32 s59, s59, s101
    s_waitcnt vmcnt(16)
    buffer_load_dwordx4 v4, s[36:39], s59 offen nt lds
    s_add_u32 m0, m0, s96
    s_add_u32 s59, s59, s98
    s_waitcnt vmcnt(16)
    buffer_load_dwordx4 v4, s[36:39], s59 offen nt lds
    s_add_u32 m0, m0, s96
    s_add_u32 s59, s59, s101
    s_waitcnt vmcnt(16)
    buffer_load_dwordx4 v4, s[36:39], s59 offen nt lds
    s_add_u32 m0, m0, s96
    s_add_u32 s59, s59, s98
    s_waitcnt vmcnt(16)
    buffer_load_dwordx4 v4, s[36:39], s59 offen nt lds
    s_add_u32 m0, m0, s96
    s_add_u32 s59, s59, s101
    s_waitcnt vmcnt(16)
    buffer_load_dwordx4 v4, s[36:39], s59 offen nt lds
    s_add_u32 m0, m0, s96
    s_add_u32 s59, s59, s98
    s_waitcnt vmcnt(16)
    buffer_load_dwordx4 v4, s[36:39], s59 offen nt lds
    s_add_u32 m0, m0, s96
    s_add_u32 s59, s59, s101
    s_waitcnt vmcnt(16)
    buffer_load_dwordx4 v4, s[36:39], s59 offen nt lds
    s_add_u32 m0, m0, s96
    s_add_u32 s59, s59, s98
    s_waitcnt vmcnt(16)
    buffer_load_dwordx4 v4, s[36:39], s59 offen nt lds
    s_add_u32 m0, m0, s96
    s_add_u32 s59, s59, s101
    s_waitcnt vmcnt(16)
    buffer_load_dwordx4 v4, s[36:39], s59 offen nt lds
    s_add_u32 m0, m0, s96
    s_add_u32 s59, s59, s98
    s_waitcnt vmcnt(16)
    buffer_load_dwordx4 v4, s[36:39], s59 offen nt lds
    s_add_u32 m0, m0, s96
    s_add_u32 s59, s59, s101
    s_waitcnt vmcnt(16)
    buffer_load_dwordx4 v4, s[36:39], s59 offen nt lds
    s_waitcnt vmcnt(16)
    v_mov_b32 v9, 32
    ds_write_b32 v8, v9 offset:0
    s_mov_b32 m0, 77824
    s_nop 0
    buffer_load_dwordx4 v4, s[40:43], s61 offen nt lds
    s_add_u32 m0, m0, s96
    s_add_u32 s61, s61, s101
    s_waitcnt vmcnt(16)
    buffer_load_dwordx4 v4, s[40:43], s61 offen nt lds
    s_add_u32 m0, m0, s96
    s_add_u32 s61, s61, s98
    s_waitcnt vmcnt(16)
    buffer_load_dwordx4 v4, s[40:43], s61 offen nt lds
    s_add_u32 m0, m0, s96
    s_add_u32 s61, s61, s101
    s_waitcnt vmcnt(16)
    buffer_load_dwordx4 v4, s[40:43], s61 offen nt lds
    s_add_u32 m0, m0, s96
    s_add_u32 s61, s61, s98
    s_waitcnt vmcnt(16)
    buffer_load_dwordx4 v4, s[40:43], s61 offen nt lds
    s_add_u32 m0, m0, s96
    s_add_u32 s61, s61, s101
    s_waitcnt vmcnt(16)
    buffer_load_dwordx4 v4, s[40:43], s61 offen nt lds
    s_add_u32 m0, m0, s96
    s_add_u32 s61, s61, s98
    s_waitcnt vmcnt(16)
    buffer_load_dwordx4 v4, s[40:43], s61 offen nt lds
    s_add_u32 m0, m0, s96
    s_add_u32 s61, s61, s101
    s_waitcnt vmcnt(16)
    buffer_load_dwordx4 v4, s[40:43], s61 offen nt lds
    s_add_u32 m0, m0, s96
    s_add_u32 s61, s61, s98
    s_waitcnt vmcnt(16)
    buffer_load_dwordx4 v4, s[40:43], s61 offen nt lds
    s_add_u32 m0, m0, s96
    s_add_u32 s61, s61, s101
    s_waitcnt vmcnt(16)
    buffer_load_dwordx4 v4, s[40:43], s61 offen nt lds
    s_add_u32 m0, m0, s96
    s_add_u32 s61, s61, s98
    s_waitcnt vmcnt(16)
    buffer_load_dwordx4 v4, s[40:43], s61 offen nt lds
    s_add_u32 m0, m0, s96
    s_add_u32 s61, s61, s101
    s_waitcnt vmcnt(16)
    buffer_load_dwordx4 v4, s[40:43], s61 offen nt lds
    s_add_u32 m0, m0, s96
    s_add_u32 s61, s61, s98
    s_waitcnt vmcnt(16)
    buffer_load_dwordx4 v4, s[40:43], s61 offen nt lds
    s_add_u32 m0, m0, s96
    s_add_u32 s61, s61, s101
    s_waitcnt vmcnt(16)
    buffer_load_dwordx4 v4, s[40:43], s61 offen nt lds
    s_add_u32 m0, m0, s96
    s_add_u32 s61, s61, s98
    s_waitcnt vmcnt(16)
    buffer_load_dwordx4 v4, s[40:43], s61 offen nt lds
    s_add_u32 m0, m0, s96
    s_add_u32 s61, s61, s101
    s_waitcnt vmcnt(16)
    buffer_load_dwordx4 v4, s[40:43], s61 offen nt lds
    s_waitcnt vmcnt(16)
    s_mov_b32 m0, 94208
    s_nop 0
    buffer_load_dwordx4 v5, s[44:47], s62 offen nt lds
    s_add_u32 m0, m0, s96
    s_add_u32 s62, s62, s99
    s_waitcnt vmcnt(16)
    buffer_load_dwordx4 v5, s[44:47], s62 offen nt lds
    s_add_u32 m0, m0, s96
    s_add_u32 s62, s62, s99
    s_waitcnt vmcnt(16)
    buffer_load_dwordx4 v5, s[44:47], s62 offen nt lds
    s_add_u32 m0, m0, s96
    s_add_u32 s62, s62, s99
    s_waitcnt vmcnt(16)
    buffer_load_dwordx4 v5, s[44:47], s62 offen nt lds
    s_add_u32 m0, m0, s96
    s_add_u32 s62, s62, s99
    s_waitcnt vmcnt(16)
    v_mov_b32 v9, 52
    ds_write_b32 v8, v9 offset:0
    buffer_load_dwordx4 v5, s[44:47], s62 offen nt lds
    s_add_u32 m0, m0, s96
    s_add_u32 s62, s62, s99
    s_waitcnt vmcnt(16)
    buffer_load_dwordx4 v5, s[44:47], s62 offen nt lds
    s_add_u32 m0, m0, s96
    s_add_u32 s62, s62, s99
    s_waitcnt vmcnt(16)
    buffer_load_dwordx4 v5, s[44:47], s62 offen nt lds
    s_add_u32 m0, m0, s96
    s_add_u32 s62, s62, s99
    s_waitcnt vmcnt(16)
    buffer_load_dwordx4 v5, s[44:47], s62 offen nt lds
    s_add_u32 m0, m0, s96
    s_add_u32 s62, s62, s99
    s_waitcnt vmcnt(16)
    buffer_load_dwordx4 v5, s[44:47], s62 offen nt lds
    s_add_u32 m0, m0, s96
    s_add_u32 s62, s62, s99
    s_waitcnt vmcnt(16)
    buffer_load_dwordx4 v5, s[44:47], s62 offen nt lds
    s_add_u32 m0, m0, s96
    s_add_u32 s62, s62, s99
    s_waitcnt vmcnt(16)
    buffer_load_dwordx4 v5, s[44:47], s62 offen nt lds
    s_add_u32 m0, m0, s96
    s_add_u32 s62, s62, s99
    s_waitcnt vmcnt(16)
    buffer_load_dwordx4 v5, s[44:47], s62 offen nt lds
    s_add_u32 m0, m0, s96
    s_add_u32 s62, s62, s99
    s_waitcnt vmcnt(16)
    buffer_load_dwordx4 v5, s[44:47], s62 offen nt lds
    s_add_u32 m0, m0, s96
    s_add_u32 s62, s62, s99
    s_waitcnt vmcnt(16)
    buffer_load_dwordx4 v5, s[44:47], s62 offen nt lds
    s_add_u32 m0, m0, s96
    s_add_u32 s62, s62, s99
    s_waitcnt vmcnt(16)
    buffer_load_dwordx4 v5, s[44:47], s62 offen nt lds
    s_add_u32 m0, m0, s96
    s_add_u32 s62, s62, s99
    s_waitcnt vmcnt(16)
    buffer_load_dwordx4 v5, s[44:47], s62 offen nt lds
    s_add_u32 m0, m0, s96
    s_add_u32 s62, s62, s99
    s_waitcnt vmcnt(16)
    v_mov_b32 v9, 64
    ds_write_b32 v8, v9 offset:0
    buffer_load_dwordx4 v5, s[44:47], s62 offen nt lds
    s_add_u32 m0, m0, s96
    s_add_u32 s62, s62, s99
    s_waitcnt vmcnt(16)
    buffer_load_dwordx4 v5, s[44:47], s62 offen nt lds
    s_add_u32 m0, m0, s96
    s_add_u32 s62, s62, s99
    s_waitcnt vmcnt(16)
    buffer_load_dwordx4 v5, s[44:47], s62 offen nt lds
    s_add_u32 m0, m0, s96
    s_add_u32 s62, s62, s99
    s_waitcnt vmcnt(16)
    buffer_load_dwordx4 v5, s[44:47], s62 offen nt lds
    s_add_u32 m0, m0, s96
    s_add_u32 s62, s62, s99
    s_waitcnt vmcnt(16)
    buffer_load_dwordx4 v5, s[44:47], s62 offen nt lds
    s_add_u32 m0, m0, s96
    s_add_u32 s62, s62, s99
    s_waitcnt vmcnt(16)
    buffer_load_dwordx4 v5, s[44:47], s62 offen nt lds
    s_add_u32 m0, m0, s96
    s_add_u32 s62, s62, s99
    s_waitcnt vmcnt(16)
    buffer_load_dwordx4 v5, s[44:47], s62 offen nt lds
    s_add_u32 m0, m0, s96
    s_add_u32 s62, s62, s99
    s_waitcnt vmcnt(16)
    buffer_load_dwordx4 v5, s[44:47], s62 offen nt lds
    s_add_u32 m0, m0, s96
    s_add_u32 s62, s62, s99
    s_waitcnt vmcnt(16)
    buffer_load_dwordx4 v5, s[44:47], s62 offen nt lds
    s_add_u32 m0, m0, s96
    s_add_u32 s62, s62, s99
    s_waitcnt vmcnt(16)
    buffer_load_dwordx4 v5, s[44:47], s62 offen nt lds
    s_add_u32 m0, m0, s96
    s_add_u32 s62, s62, s99
    s_waitcnt vmcnt(16)
    buffer_load_dwordx4 v5, s[44:47], s62 offen nt lds
    s_add_u32 m0, m0, s96
    s_add_u32 s62, s62, s99
    s_waitcnt vmcnt(16)
    buffer_load_dwordx4 v5, s[44:47], s62 offen nt lds
    s_add_u32 m0, m0, s96
    s_add_u32 s62, s62, s99
    ds_read_b32 v11, v8 offset:8
    s_waitcnt vmcnt(16)
    buffer_load_dwordx4 v5, s[44:47], s62 offen nt lds
    s_add_u32 m0, m0, s96
    s_add_u32 s62, s62, s99
    s_waitcnt vmcnt(16)
    buffer_load_dwordx4 v5, s[44:47], s62 offen nt lds
    s_add_u32 m0, m0, s96
    s_add_u32 s62, s62, s99
    s_waitcnt lgkmcnt(0)
    v_readfirstlane_b32 s56, v11
    s_waitcnt vmcnt(16)
    buffer_load_dwordx4 v5, s[44:47], s62 offen nt lds
    s_add_u32 m0, m0, s96
    s_add_u32 s62, s62, s99
    s_waitcnt vmcnt(16)
    buffer_load_dwordx4 v5, s[44:47], s62 offen nt lds
    s_waitcnt vmcnt(16)
    s_mov_b32 m0, 0
    s_nop 0
    buffer_load_dwordx4 v6, s[48:51], s63 offen nt lds
    s_add_u32 m0, m0, s96
    s_add_u32 s63, s63, s101
    s_waitcnt vmcnt(16)
    buffer_load_dwordx4 v6, s[48:51], s63 offen nt lds
    s_add_u32 m0, m0, s96
    s_add_u32 s63, s63, s101
    s_waitcnt vmcnt(16)
    buffer_load_dwordx4 v6, s[48:51], s63 offen nt lds
    s_add_u32 m0, m0, s96
    s_add_u32 s63, s63, s101
    s_waitcnt vmcnt(16)
    buffer_load_dwordx4 v6, s[48:51], s63 offen nt lds
    s_add_u32 m0, m0, s96
    s_add_u32 s63, s63, s100
    s_waitcnt vmcnt(16)
    buffer_load_dwordx4 v6, s[48:51], s63 offen nt lds
    s_add_u32 m0, m0, s96
    s_add_u32 s63, s63, s101
    s_waitcnt vmcnt(16)
    buffer_load_dwordx4 v6, s[48:51], s63 offen nt lds
    s_add_u32 m0, m0, s96
    s_add_u32 s63, s63, s101
    s_waitcnt vmcnt(16)
    buffer_load_dwordx4 v6, s[48:51], s63 offen nt lds
    s_add_u32 m0, m0, s96
    s_add_u32 s63, s63, s101
    s_waitcnt vmcnt(16)
    buffer_load_dwordx4 v6, s[48:51], s63 offen nt lds
    s_add_u32 m0, m0, s96
    s_add_u32 s63, s63, s100
    s_waitcnt vmcnt(16)
    buffer_load_dwordx4 v6, s[48:51], s63 offen nt lds
    s_add_u32 m0, m0, s96
    s_add_u32 s63, s63, s101
    s_waitcnt vmcnt(16)
    buffer_load_dwordx4 v6, s[48:51], s63 offen nt lds
    s_add_u32 m0, m0, s96
    s_add_u32 s63, s63, s101
    s_waitcnt vmcnt(16)
    buffer_load_dwordx4 v6, s[48:51], s63 offen nt lds
    s_add_u32 m0, m0, s96
    s_add_u32 s63, s63, s101
    s_waitcnt vmcnt(16)
    buffer_load_dwordx4 v6, s[48:51], s63 offen nt lds
    s_add_u32 m0, m0, s96
    s_add_u32 s63, s63, s100
    s_waitcnt vmcnt(16)
    buffer_load_dwordx4 v6, s[48:51], s63 offen nt lds
    s_add_u32 m0, m0, s96
    s_add_u32 s63, s63, s101
    s_waitcnt vmcnt(16)
    buffer_load_dwordx4 v6, s[48:51], s63 offen nt lds
    s_add_u32 m0, m0, s96
    s_add_u32 s63, s63, s101
    s_waitcnt vmcnt(16)
    buffer_load_dwordx4 v6, s[48:51], s63 offen nt lds
    s_add_u32 m0, m0, s96
    s_add_u32 s63, s63, s101
    s_waitcnt vmcnt(16)
    buffer_load_dwordx4 v6, s[48:51], s63 offen nt lds
    s_add_u32 m0, m0, s96
    s_add_u32 s63, s63, s100
    ds_read_b32 v11, v8 offset:8
    s_waitcnt vmcnt(16)
    v_mov_b32 v9, 96
    ds_write_b32 v8, v9 offset:0
    buffer_load_dwordx4 v6, s[48:51], s63 offen nt lds
    s_add_u32 m0, m0, s96
    s_add_u32 s63, s63, s101
    s_waitcnt vmcnt(16)
    buffer_load_dwordx4 v6, s[48:51], s63 offen nt lds
    s_add_u32 m0, m0, s96
    s_add_u32 s63, s63, s101
    s_waitcnt lgkmcnt(0)
    v_readfirstlane_b32 s58, v11
    ds_write_b32 v8, v11 offset:24
    s_waitcnt vmcnt(16)
    buffer_load_dwordx4 v6, s[48:51], s63 offen nt lds
    s_add_u32 m0, m0, s96
    s_add_u32 s63, s63, s101
    s_waitcnt vmcnt(16)
    buffer_load_dwordx4 v6, s[48:51], s63 offen nt lds
    s_add_u32 m0, m0, s96
    s_add_u32 s63, s63, s100
    s_waitcnt vmcnt(16)
    buffer_load_dwordx4 v6, s[48:51], s63 offen nt lds
    s_add_u32 m0, m0, s96
    s_add_u32 s63, s63, s101
    s_waitcnt vmcnt(16)
    buffer_load_dwordx4 v6, s[48:51], s63 offen nt lds
    s_add_u32 m0, m0, s96
    s_add_u32 s63, s63, s101
    s_waitcnt vmcnt(16)
    buffer_load_dwordx4 v6, s[48:51], s63 offen nt lds
    s_add_u32 m0, m0, s96
    s_add_u32 s63, s63, s101
    s_waitcnt vmcnt(16)
    buffer_load_dwordx4 v6, s[48:51], s63 offen nt lds
    s_add_u32 m0, m0, s96
    s_add_u32 s63, s63, s100
    s_waitcnt vmcnt(16)
    buffer_load_dwordx4 v6, s[48:51], s63 offen nt lds
    s_add_u32 m0, m0, s96
    s_add_u32 s63, s63, s101
    s_waitcnt vmcnt(16)
    buffer_load_dwordx4 v6, s[48:51], s63 offen nt lds
    s_add_u32 m0, m0, s96
    s_add_u32 s63, s63, s101
    s_waitcnt vmcnt(16)
    buffer_load_dwordx4 v6, s[48:51], s63 offen nt lds
    s_add_u32 m0, m0, s96
    s_add_u32 s63, s63, s101
    s_waitcnt vmcnt(16)
    buffer_load_dwordx4 v6, s[48:51], s63 offen nt lds
    s_waitcnt vmcnt(16)
    s_mov_b32 m0, 126976
    s_nop 0
    buffer_load_dwordx4 v6, s[52:55], s31 offen nt lds
    s_add_u32 m0, m0, s96
    s_add_u32 s31, s31, s101
    s_waitcnt vmcnt(16)
    buffer_load_dwordx4 v6, s[52:55], s31 offen nt lds
    s_add_u32 m0, m0, s96
    s_add_u32 s31, s31, s101
    s_waitcnt vmcnt(16)
    buffer_load_dwordx4 v6, s[52:55], s31 offen nt lds
    s_add_u32 m0, m0, s96
    s_add_u32 s31, s31, s101
    s_waitcnt vmcnt(16)
    buffer_load_dwordx4 v6, s[52:55], s31 offen nt lds
    s_add_u32 m0, m0, s96
    s_add_u32 s31, s31, s100
    s_waitcnt vmcnt(16)
    v_mov_b32 v9, 112
    ds_write_b32 v8, v9 offset:0
    buffer_load_dwordx4 v6, s[52:55], s31 offen nt lds
    s_add_u32 m0, m0, s96
    s_add_u32 s31, s31, s101
    s_waitcnt vmcnt(16)
    buffer_load_dwordx4 v6, s[52:55], s31 offen nt lds
    s_add_u32 m0, m0, s96
    s_add_u32 s31, s31, s101
    s_waitcnt vmcnt(16)
    buffer_load_dwordx4 v6, s[52:55], s31 offen nt lds
    s_add_u32 m0, m0, s96
    s_add_u32 s31, s31, s101
    s_waitcnt vmcnt(16)
    buffer_load_dwordx4 v6, s[52:55], s31 offen nt lds
    s_add_u32 m0, m0, s96
    s_add_u32 s31, s31, s100
    s_waitcnt vmcnt(16)
    buffer_load_dwordx4 v6, s[52:55], s31 offen nt lds
    s_add_u32 m0, m0, s96
    s_add_u32 s31, s31, s101
    s_waitcnt vmcnt(16)
    buffer_load_dwordx4 v6, s[52:55], s31 offen nt lds
    s_add_u32 m0, m0, s96
    s_add_u32 s31, s31, s101
    s_waitcnt vmcnt(16)
    buffer_load_dwordx4 v6, s[52:55], s31 offen nt lds
    s_add_u32 m0, m0, s96
    s_add_u32 s31, s31, s101
    s_waitcnt vmcnt(16)
    buffer_load_dwordx4 v6, s[52:55], s31 offen nt lds
    s_add_u32 m0, m0, s96
    s_add_u32 s31, s31, s100
    s_waitcnt vmcnt(16)
    s_cmp_ge_u32 s56, 4
    s_cselect_b32 s57, 1, 0
    v_mov_b32 v10, s57
    ds_write_b32 v8, v10 offset:28
    buffer_load_dwordx4 v6, s[52:55], s31 offen nt lds
    s_add_u32 m0, m0, s96
    s_add_u32 s31, s31, s101
    s_waitcnt vmcnt(16)
    buffer_load_dwordx4 v6, s[52:55], s31 offen nt lds
    s_add_u32 m0, m0, s96
    s_add_u32 s31, s31, s101
    s_waitcnt vmcnt(16)
    buffer_load_dwordx4 v6, s[52:55], s31 offen nt lds
    s_add_u32 m0, m0, s96
    s_add_u32 s31, s31, s101
    s_waitcnt vmcnt(16)
    buffer_load_dwordx4 v6, s[52:55], s31 offen nt lds
    s_add_u32 m0, m0, s96
    s_add_u32 s31, s31, s100
    s_waitcnt vmcnt(16)
    v_mov_b32 v9, 124
    ds_write_b32 v8, v9 offset:0
    s_cmp_ge_u32 s58, 4
    s_cselect_b32 s57, 1, 0
    s_cmp_ge_u32 s56, 4
    s_cselect_b32 s57, 1, s57
    v_mov_b32 v10, s57
    ds_write_b32 v8, v10 offset:28
    buffer_load_dwordx4 v6, s[52:55], s31 offen nt lds
    s_add_u32 m0, m0, s96
    s_add_u32 s31, s31, s101
    s_waitcnt vmcnt(16)
    buffer_load_dwordx4 v6, s[52:55], s31 offen nt lds
    s_add_u32 m0, m0, s96
    s_add_u32 s31, s31, s101
    s_waitcnt vmcnt(16)
    s_cmp_ge_u32 s58, 4
    s_cselect_b32 s57, 1, 0
    s_cmp_ge_u32 s56, 4
    s_cselect_b32 s57, 2, s57
    v_mov_b32 v10, s57
    ds_write_b32 v8, v10 offset:28
    buffer_load_dwordx4 v6, s[52:55], s31 offen nt lds
    s_add_u32 m0, m0, s96
    s_add_u32 s31, s31, s101
    s_waitcnt vmcnt(16)
    buffer_load_dwordx4 v6, s[52:55], s31 offen nt lds
    s_add_u32 m0, m0, s96
    s_add_u32 s31, s31, s100
    s_waitcnt vmcnt(16)
    buffer_load_dwordx4 v6, s[52:55], s31 offen nt lds
    s_add_u32 m0, m0, s96
    s_add_u32 s31, s31, s101
    s_waitcnt vmcnt(16)
    buffer_load_dwordx4 v6, s[52:55], s31 offen nt lds
    s_add_u32 m0, m0, s96
    s_add_u32 s31, s31, s101
    s_waitcnt vmcnt(16)
    buffer_load_dwordx4 v6, s[52:55], s31 offen nt lds
    s_add_u32 m0, m0, s96
    s_add_u32 s31, s31, s101
    s_waitcnt vmcnt(16)
    buffer_load_dwordx4 v6, s[52:55], s31 offen nt lds
    s_add_u32 m0, m0, s96
    s_add_u32 s31, s31, s100
    s_waitcnt vmcnt(16)
    buffer_load_dwordx4 v6, s[52:55], s31 offen nt lds
    s_add_u32 m0, m0, s96
    s_add_u32 s31, s31, s101
    s_waitcnt vmcnt(16)
    buffer_load_dwordx4 v6, s[52:55], s31 offen nt lds
    s_add_u32 m0, m0, s96
    s_add_u32 s31, s31, s101
    s_waitcnt vmcnt(16)
    buffer_load_dwordx4 v6, s[52:55], s31 offen nt lds
    s_add_u32 m0, m0, s96
    s_add_u32 s31, s31, s101
    s_waitcnt vmcnt(16)
    buffer_load_dwordx4 v6, s[52:55], s31 offen nt lds
    s_add_u32 m0, m0, s96
    s_add_u32 s31, s31, s100
    s_waitcnt vmcnt(16)
    buffer_load_dwordx4 v6, s[52:55], s31 offen nt lds
    s_add_u32 m0, m0, s96
    s_add_u32 s31, s31, s101
    s_waitcnt vmcnt(16)
    buffer_load_dwordx4 v6, s[52:55], s31 offen nt lds
    s_add_u32 m0, m0, s96
    s_add_u32 s31, s31, s101
    s_waitcnt vmcnt(16)
    buffer_load_dwordx4 v6, s[52:55], s31 offen nt lds
    s_add_u32 m0, m0, s96
    s_add_u32 s31, s31, s101
    s_waitcnt vmcnt(16)
    buffer_load_dwordx4 v6, s[52:55], s31 offen nt lds
    s_waitcnt vmcnt(16)
    v_mov_b32 v9, 140
    ds_write_b32 v8, v9 offset:0
    s_cmp_ge_u32 s58, 4
    s_cselect_b32 s57, 2, 1
    s_cmp_ge_u32 s56, 4
    s_cselect_b32 s57, 2, s57
    v_mov_b32 v10, s57
    ds_write_b32 v8, v10 offset:28
    s_waitcnt vmcnt(0)
    v_mov_b32 v9, 156
    ds_write_b32 v8, v9 offset:0
    v_mov_b32 v10, 3
    ds_write_b32 v8, v10 offset:28
    s_waitcnt lgkmcnt(0)
    s_branch Lfin
Lteam:
Lnox:
    s_barrier
    v_mov_b32 v8, 159744
    v_mov_b32 v11, 1
    s_waitcnt lgkmcnt(0)
    s_load_dword s48, s[28:29], 0
    v_lshrrev_b32 v1, 3, v0
    v_lshl_add_u32 v125, v1, 6, v8
    v_and_b32 v1, 3, v0
    v_lshl_add_u32 v125, v1, 4, v125
    v_bfe_u32 v1, v0, 2, 1
    v_lshl_add_u32 v125, v1, 3, v125
    s_and_b32 s44, s3, 6
    s_nop 0
    s_cbranch_scc1 Lnoln
    s_waitcnt vmcnt(0)
    v_lshlrev_b32 v24, 16, v12
    v_and_b32 v25, 0xffff0000, v12
    v_lshlrev_b32 v26, 16, v13
    v_and_b32 v27, 0xffff0000, v13
    v_lshlrev_b32 v28, 16, v14
    v_and_b32 v29, 0xffff0000, v14
    v_lshlrev_b32 v30, 16, v15
    v_and_b32 v31, 0xffff0000, v15
    v_lshlrev_b32 v32, 16, v16
    v_and_b32 v33, 0xffff0000, v16
    v_lshlrev_b32 v34, 16, v17
    v_and_b32 v35, 0xffff0000, v17
    v_lshlrev_b32 v36, 16, v18
    v_and_b32 v37, 0xffff0000, v18
    v_lshlrev_b32 v38, 16, v19
    v_and_b32 v39, 0xffff0000, v19
    v_add_f32 v40, v24, v25
    v_add_f32 v41, v26, v27
    v_add_f32 v40, v40, v28
    v_add_f32 v41, v41, v29
    v_add_f32 v40, v40, v30
    v_add_f32 v41, v41, v31
    v_add_f32 v40, v40, v32
    v_add_f32 v41, v41, v33
    v_add_f32 v40, v40, v34
    v_add_f32 v41, v41, v35
    v_add_f32 v40, v40, v36
    v_add_f32 v41, v41, v37
    v_add_f32 v40, v40, v38
    v_add_f32 v41, v41, v39
    v_add_f32 v40, v40, v41
    s_nop 1
    v_add_f32_dpp v40, v40, v40 row_ror:8 row_mask:0xf bank_mask:0xf
    s_nop 1
    v_add_f32_dpp v40, v40, v40 row_ror:4 row_mask:0xf bank_mask:0xf
    s_nop 1
    v_add_f32_dpp v40, v40, v40 row_ror:2 row_mask:0xf bank_mask:0xf
    s_nop 1
    v_add_f32_dpp v40, v40, v40 row_ror:1 row_mask:0xf bank_mask:0xf
    v_mov_b32 v41, v40
    s_nop 1
    v_permlane16_swap_b32 v40, v41
    v_add_f32 v40, v40, v41
    v_mov_b32 v41, v40
    s_nop 1
    v_permlane32_swap_b32 v40, v41
    v_add_f32 v40, v40, v41
    v_mul_f32 v40, 0x3a800000, v40
    v_sub_f32 v24, v24, v40
    v_sub_f32 v25, v25, v40
    v_sub_f32 v26, v26, v40
    v_sub_f32 v27, v27, v40
    v_sub_f32 v28, v28, v40
    v_sub_f32 v29, v29, v40
    v_sub_f32 v30, v30, v40
    v_sub_f32 v31, v31, v40
    v_sub_f32 v32, v32, v40
    v_sub_f32 v33, v33, v40
    v_sub_f32 v34, v34, v40
    v_sub_f32 v35, v35, v40
    v_sub_f32 v36, v36, v40
    v_sub_f32 v37, v37, v40
    v_sub_f32 v38, v38, v40
    v_sub_f32 v39, v39, v40
    v_mul_f32 v42, v24, v24
    v_mul_f32 v41, v25, v25
    v_fmac_f32 v42, v26, v26
    v_fmac_f32 v41, v27, v27
    v_fmac_f32 v42, v28, v28
    v_fmac_f32 v41, v29, v29
    v_fmac_f32 v42, v30, v30
    v_fmac_f32 v41, v31, v31
    v_fmac_f32 v42, v32, v32
    v_fmac_f32 v41, v33, v33
    v_fmac_f32 v42, v34, v34
    v_fmac_f32 v41, v35, v35
    v_fmac_f32 v42, v36, v36
    v_fmac_f32 v41, v37, v37
    v_fmac_f32 v42, v38, v38
    v_fmac_f32 v41, v39, v39
    v_add_f32 v42, v42, v41
    s_nop 1
    v_add_f32_dpp v42, v42, v42 row_ror:8 row_mask:0xf bank_mask:0xf
    s_nop 1
    v_add_f32_dpp v42, v42, v42 row_ror:4 row_mask:0xf bank_mask:0xf
    s_nop 1
    v_add_f32_dpp v42, v42, v42 row_ror:2 row_mask:0xf bank_mask:0xf
    s_nop 1
    v_add_f32_dpp v42, v42, v42 row_ror:1 row_mask:0xf bank_mask:0xf
    v_mov_b32 v41, v42
    s_nop 1
    v_permlane16_swap_b32 v42, v41
    v_add_f32 v42, v42, v41
    v_mov_b32 v41, v42
    s_nop 1
    v_permlane32_swap_b32 v42, v41
    v_add_f32 v42, v42, v41
    v_mul_f32 v42, 0x3a800000, v42
    v_cvt_pk_bf16_f32 v40, v40, v42
    v_and_b32 v42, 0xffff0000, v40
    v_lshlrev_b32 v40, 16, v40
    v_add_f32 v42, 0x3727c5ac, v42
    v_cvt_pk_bf16_f32 v42, v42, v42
    v_lshlrev_b32 v42, 16, v42
    v_sqrt_f32 v42, v42
    s_nop 0
    v_cvt_pk_bf16_f32 v42, v42, v42
    v_lshlrev_b32 v42, 16, v42
    v_rcp_f32 v42, v42
    v_lshlrev_b32 v24, 16, v20
    v_and_b32 v25, 0xffff0000, v20
    v_lshlrev_b32 v26, 16, v21
    v_and_b32 v27, 0xffff0000, v21
    v_sub_f32 v24, v24, v40
    v_sub_f32 v25, v25, v40
    v_sub_f32 v26, v26, v40
    v_sub_f32 v27, v27, v40
    v_cvt_pk_bf16_f32 v22, v24, v25
    v_cvt_pk_bf16_f32 v23, v26, v27
    v_lshlrev_b32 v24, 16, v22
    v_and_b32 v25, 0xffff0000, v22
    v_lshlrev_b32 v26, 16, v23
    v_and_b32 v27, 0xffff0000, v23
    v_mul_f32 v24, v24, v42
    v_mul_f32 v25, v25, v42
    v_mul_f32 v26, v26, v42
    v_mul_f32 v27, v27, v42
    v_cvt_pk_bf16_f32 v22, v24, v25
    v_cvt_pk_bf16_f32 v23, v26, v27
    s_cmp_eq_u32 s3, 1
    s_nop 0
    s_cbranch_scc0 Lnoln
    ds_write_b64 v125, v[22:23] offset:64
    ds_write_b32 v8, v11 offset:4
Lnoln:
    s_lshr_b32 s5, s2, 2
    s_bfe_u32 s6, s2, 0x20001
    s_lshr_b32 s7, s2, 3
    s_lshl_b32 s7, s7, 1
    s_and_b32 s30, s2, 1
    s_add_u32 s7, s7, s30
    s_lshr_b32 s26, s2, 5
    s_lshl_b32 s26, s26, 3
    s_and_b32 s30, s2, 7
    s_add_u32 s26, s26, s30
    s_bfe_u32 s27, s2, 0x20003
    s_sub_u32 s31, s3, 1
    s_lshr_b32 s30, s31, 2
    s_and_b32 s31, s31, 3
    v_and_b32 v1, 15, v0
    v_lshrrev_b32 v2, 4, v0
    v_bfe_u32 v3, v0, 2, 3
    v_and_b32 v4, 6, v3
    v_bfe_u32 v5, v0, 1, 1
    v_xor_b32 v4, v4, v5
    v_lshlrev_b32 v3, 7, v3
    v_lshl_add_u32 v3, v4, 4, v3
    v_and_b32 v4, 1, v0
    v_lshl_add_u32 v3, v4, 3, v3
    v_lshrrev_b32 v4, 5, v0
    v_and_b32 v5, 3, v0
    v_and_b32 v6, 1, v2
    v_lshlrev_b32 v6, 2, v6
    v_lshl_add_u32 v5, v5, 3, v6
    s_lshl_b32 s44, s26, 5
    v_add_u32 v126, s44, v5
    s_cmp_eq_u32 s3, 5
    s_nop 0
    s_cbranch_scc0 Lnof
    buffer_load_dword v127, v126, s[40:43], 0 offen
Lnof:
    s_mov_b32 s36, s28
    s_and_b32 s37, s29, 0xffff
    s_mov_b32 s38, 2097152
    s_mov_b32 s39, 0x20000
    s_cmp_eq_u32 s30, 0
    s_mov_b32 s44, 94208
    s_cmov_b32 s44, 28672
    s_mov_b32 s45, 69632
    s_cmov_b32 s45, 4096
    s_movk_i32 s46, 96
    s_cmovk_i32 s46, 32
    s_lshl_b32 s47, s31, 5
    v_xor_b32 v5, s47, v3
    v_lshl_add_u32 v5, v4, 10, v5
    v_add_u32 v5, s44, v5
    v_lshl_add_u32 v6, v2, 4, v8
    s_lshl_b32 s44, s4, 14
    s_add_u32 s45, s45, s44
    s_lshl_b32 s44, s5, 8
    s_add_u32 s45, s45, s44
    s_lshl_b32 s44, s31, 6
    s_add_u32 s45, s45, s44
    v_lshl_add_u32 v7, v1, 2, s45
    s_waitcnt lgkmcnt(0)
    s_add_u32 s48, s48, 1
    s_and_b32 s48, s48, 0xff
    s_mul_i32 s50, s48, 0x01010101
    s_mov_b32 s49, 0xffffff00
    v_mov_b32 v10, s48
    s_cmp_ge_u32 s2, 224
    s_cselect_b32 s44, s30, 0
    s_cmp_lg_u32 s44, 0
    s_cbranch_scc1 Lmid
    s_mov_b32 s58, 100000
Lsp1:
    ds_read_b32 v9, v8 offset:4
    s_waitcnt lgkmcnt(0)
    v_readfirstlane_b32 s59, v9
    s_nop 0
    s_cmp_ge_u32 s59, 1
    s_nop 2
    s_cbranch_scc1 Lsd2
    s_sleep 1
    s_sub_u32 s58, s58, 1
    s_cbranch_scc0 Lsp1
Lsd2:
    ds_read_b128 v[12:15], v6 offset:64
    ds_read_b128 v[16:19], v6 offset:128
    ds_read_b128 v[20:23], v6 offset:192
    ds_read_b128 v[24:27], v6 offset:256
    ds_read_b128 v[28:31], v6 offset:320
    ds_read_b128 v[32:35], v6 offset:384
    ds_read_b128 v[36:39], v6 offset:448
    ds_read_b128 v[40:43], v6 offset:512
    s_mov_b32 s58, 100000
Lsp3:
    ds_read_b32 v9, v8 offset:0
    s_waitcnt lgkmcnt(0)
    v_readfirstlane_b32 s59, v9
    s_nop 0
    s_cmp_ge_u32 s59, s46
    s_nop 2
    s_cbranch_scc1 Lsd4
    s_sleep 1
    s_sub_u32 s58, s58, 1
    s_cbranch_scc0 Lsp3
Lsd4:
    ds_read_b64_tr_b16 v[44:45], v5 offset:0
    ds_read_b64_tr_b16 v[46:47], v5 offset:2048
    ds_read_b64_tr_b16 v[48:49], v5 offset:4096
    ds_read_b64_tr_b16 v[50:51], v5 offset:6144
    ds_read_b64_tr_b16 v[52:53], v5 offset:8192
    ds_read_b64_tr_b16 v[54:55], v5 offset:10240
    ds_read_b64_tr_b16 v[56:57], v5 offset:12288
    ds_read_b64_tr_b16 v[58:59], v5 offset:14336
    ds_read_b64_tr_b16 v[60:61], v5 offset:16384
    ds_read_b64_tr_b16 v[62:63], v5 offset:18432
    ds_read_b64_tr_b16 v[64:65], v5 offset:20480
    ds_read_b64_tr_b16 v[66:67], v5 offset:22528
    ds_read_b64_tr_b16 v[68:69], v5 offset:24576
    ds_read_b64_tr_b16 v[70:71], v5 offset:26624
    ds_read_b64_tr_b16 v[72:73], v5 offset:28672
    ds_read_b64_tr_b16 v[74:75], v5 offset:30720
    s_waitcnt lgkmcnt(14)
    v_mfma_f32_16x16x32_bf16 v[76:79], v[12:15], v[44:47], 0
    s_waitcnt lgkmcnt(12)
    v_mfma_f32_16x16x32_bf16 v[80:83], v[16:19], v[48:51], 0
    s_waitcnt lgkmcnt(10)
    v_mfma_f32_16x16x32_bf16 v[76:79], v[20:23], v[52:55], v[76:79]
    s_waitcnt lgkmcnt(8)
    v_mfma_f32_16x16x32_bf16 v[80:83], v[24:27], v[56:59], v[80:83]
    s_waitcnt lgkmcnt(6)
    v_mfma_f32_16x16x32_bf16 v[76:79], v[28:31], v[60:63], v[76:79]
    s_waitcnt lgkmcnt(4)
    v_mfma_f32_16x16x32_bf16 v[80:83], v[32:35], v[64:67], v[80:83]
    s_waitcnt lgkmcnt(2)
    v_mfma_f32_16x16x32_bf16 v[76:79], v[36:39], v[68:71], v[76:79]
    s_waitcnt lgkmcnt(0)
    v_mfma_f32_16x16x32_bf16 v[80:83], v[40:43], v[72:75], v[80:83]
    s_nop 7
    v_add_f32 v76, v76, v80
    v_bfi_b32 v76, s49, v76, v10
    s_mov_b64 exec, 0xffff
    buffer_store_dword v76, v7, s[36:39], 0 offen sc1
    s_mov_b64 exec, -1
Lmid:
    s_cmp_eq_u32 s30, 0
    s_cbranch_scc0 Lmlp
    v_and_b32 v5, 6, v0
    v_xor_b32 v5, v5, v2
    v_lshlrev_b32 v5, 4, v5
    v_and_b32 v6, 7, v0
    v_lshl_add_u32 v5, v6, 7, v5
    v_bfe_u32 v6, v0, 3, 1
    v_lshl_add_u32 v5, v6, 11, v5
    v_add_u32 v5, 61440, v5
    v_xor_b32 v6, 64, v5
    s_and_b32 s44, s31, 1
    s_lshl_b32 s44, s44, 6
    s_lshr_b32 s45, s31, 1
    s_lshl_b32 s45, s45, 10
    s_add_u32 s45, s45, 77824
    v_xor_b32 v7, s44, v3
    v_lshl_add_u32 v7, v4, 11, v7
    v_add_u32 v7, s45, v7
    v_xor_b32 v12, 32, v7
    s_lshl_b32 s44, s6, 12
    s_lshl_b32 s45, s31, 10
    s_add_u32 s44, s44, s45
    s_add_u32 s44, s44, 4096
    v_lshl_add_u32 v13, v0, 4, s44
    s_movk_i32 s45, 272
    s_mul_i32 s44, s31, 544
    v_and_b32 v14, 31, v0
    v_lshl_add_u32 v14, v14, 3, v8
    v_mad_u32_u24 v14, v4, s45, v14
    v_add_u32 v14, s44, v14
    v_and_b32 v15, 7, v0
    v_mad_u32_u24 v15, v15, s45, v8
    v_lshl_add_u32 v15, v2, 4, v15
    s_movk_i32 s52, 0x4000
    s_mov_b32 s53, 0x8000
    s_mov_b32 s54, 0xc000
    s_mov_b32 s55, 0x10000
    s_mov_b32 s51, 0x18000
    s_mov_b32 s56, 0x3db504f3
    s_mov_b32 s57, 0x3fb8aa3b
    s_mov_b32 s58, 100000
Lsp5:
    ds_read_b32 v9, v8 offset:0
    s_waitcnt lgkmcnt(0)
    v_readfirstlane_b32 s59, v9
    s_nop 0
    s_cmp_ge_u32 s59, 52
    s_nop 2
    s_cbranch_scc1 Lsd6
    s_sleep 1
    s_sub_u32 s58, s58, 1
    s_cbranch_scc0 Lsp5
Lsd6:
    buffer_load_dwordx4 v[16:19], v13, s[36:39], 0 offen sc1
    buffer_load_dwordx4 v[20:23], v13, s[36:39], s52 offen sc1
    buffer_load_dwordx4 v[24:27], v13, s[36:39], s53 offen sc1
    buffer_load_dwordx4 v[28:31], v13, s[36:39], s54 offen sc1
    ds_read_b128 v[64:67], v5 offset:0
    ds_read_b128 v[68:71], v6 offset:0
    ds_read_b128 v[72:75], v5 offset:1024
    ds_read_b128 v[76:79], v6 offset:1024
    ds_read_b128 v[80:83], v5 offset:4096
    ds_read_b128 v[84:87], v6 offset:4096
    ds_read_b128 v[88:91], v5 offset:5120
    ds_read_b128 v[92:95], v6 offset:5120
    ds_read_b128 v[96:99], v5 offset:8192
    ds_read_b128 v[100:103], v6 offset:8192
    ds_read_b128 v[104:107], v5 offset:9216
    ds_read_b128 v[108:111], v6 offset:9216
    ds_read_b128 v[112:115], v5 offset:12288
    ds_read_b128 v[116:119], v6 offset:12288
    ds_read_b128 v[120:123], v5 offset:13312
    ds_read_b128 v[124:127], v6 offset:13312
    v_mov_b32 v62, v7
    v_mov_b32 v63, v12
    s_mov_b32 s58, 100000
    s_nop 0
Lpl7:
    s_waitcnt vmcnt(0)
    v_bitop3_b32 v32, v16, v17, s48 bitop3:0x7e
    v_bitop3_b32 v33, v18, v19, s48 bitop3:0x7e
    v_bitop3_b32 v34, v20, v21, s48 bitop3:0x7e
    v_or3_b32 v32, v32, v33, v34
    v_bitop3_b32 v33, v22, v23, s48 bitop3:0x7e
    v_bitop3_b32 v34, v24, v25, s48 bitop3:0x7e
    v_or3_b32 v32, v32, v33, v34
    v_bitop3_b32 v33, v26, v27, s48 bitop3:0x7e
    v_bitop3_b32 v34, v28, v29, s48 bitop3:0x7e
    v_or3_b32 v32, v32, v33, v34
    v_bitop3_b32 v33, v30, v31, s48 bitop3:0x7e
    v_or_b32 v32, v32, v33
    v_and_b32 v32, 0xff, v32
    v_cmp_ne_u32 vcc, 0, v32
    s_nop 4
    s_cbranch_vccz Lpd8
    s_sleep 1
    s_mov_b64 exec, vcc
    buffer_load_dwordx4 v[16:19], v13, s[36:39], 0 offen sc1
    buffer_load_dwordx4 v[20:23], v13, s[36:39], s52 offen sc1
    buffer_load_dwordx4 v[24:27], v13, s[36:39], s53 offen sc1
    buffer_load_dwordx4 v[28:31], v13, s[36:39], s54 offen sc1
    s_mov_b64 exec, -1
    s_sub_u32 s58, s58, 1
    s_cbranch_scc0 Lpl7
Lpd8:
    v_add_f32 v16, v16, v20
    v_add_f32 v24, v24, v28
    v_add_f32 v17, v17, v21
    v_add_f32 v25, v25, v29
    v_add_f32 v18, v18, v22
    v_add_f32 v26, v26, v30
    v_add_f32 v19, v19, v23
    v_add_f32 v27, v27, v31
    v_add_f32 v16, v16, v24
    v_add_f32 v17, v17, v25
    v_add_f32 v18, v18, v26
    v_add_f32 v19, v19, v27
    v_cvt_pk_bf16_f32 v16, v16, v17
    v_cvt_pk_bf16_f32 v17, v18, v19
    ds_write_b64 v14, v[16:17] offset:1024
    s_mov_b64 exec, 1
    ds_add_u32 v8, v11 offset:8
    s_mov_b64 exec, -1
    s_lshl_b32 s44, s6, 4
    s_lshr_b32 s45, s31, 1
    s_add_u32 s44, s44, s45
    s_lshl_b32 s44, s44, 14
    s_and_b32 s45, s31, 1
    s_lshl_b32 s45, s45, 13
    s_add_u32 s44, s44, s45
    s_and_b32 s45, s7, 3
    s_lshl_b32 s45, s45, 10
    s_add_u32 s44, s44, s45
    s_lshr_b32 s45, s7, 2
    s_lshl_b32 s45, s45, 6
    s_add_u32 s44, s44, s45
    s_add_u32 s44, s44, 262144
    v_and_b32 v5, 7, v0
    v_lshlrev_b32 v5, 15, v5
    v_bfe_u32 v6, v0, 3, 1
    v_lshl_add_u32 v5, v6, 12, v5
    v_lshl_add_u32 v5, v2, 4, v5
    v_add_u32 v5, s44, v5
    s_lshl_b32 s45, s31, 1
    v_lshrrev_b32 v7, 2, v0
    v_add_u32 v7, s45, v7
    s_lshl_b32 s44, s6, 13
    s_lshl_b32 s45, s7, 4
    s_add_u32 s44, s44, s45
    s_add_u32 s44, s44, 1310720
    v_lshl_add_u32 v6, v7, 10, s44
    v_and_b32 v12, 3, v0
    v_lshl_add_u32 v6, v12, 4, v6
    v_lshlrev_b32 v7, 2, v7
    v_cmp_lt_u32 vcc, 7, v1
    s_mov_b32 s58, 100000
    s_nop 3
Lsp9:
    ds_read_b32 v9, v8 offset:8
    ds_read_b128 v[16:19], v15 offset:1024
    ds_read_b128 v[20:23], v15 offset:1088
    ds_read_b128 v[24:27], v15 offset:1152
    ds_read_b128 v[28:31], v15 offset:1216
    s_waitcnt lgkmcnt(0)
    v_readfirstlane_b32 s59, v9
    s_nop 0
    s_cmp_ge_u32 s59, 4
    s_nop 2
    s_cbranch_scc1 Lsd10
    s_sleep 1
    s_sub_u32 s58, s58, 1
    s_cbranch_scc0 Lsp9
Lsd10:
    v_mfma_f32_16x16x32_bf16 v[32:35], v[64:67], v[16:19], 0
    v_mfma_f32_16x16x32_bf16 v[36:39], v[80:83], v[16:19], 0
    v_mfma_f32_16x16x32_bf16 v[40:43], v[96:99], v[16:19], 0
    v_mfma_f32_16x16x32_bf16 v[44:47], v[112:115], v[16:19], 0
    v_mfma_f32_16x16x32_bf16 v[32:35], v[68:71], v[20:23], v[32:35]
    v_mfma_f32_16x16x32_bf16 v[36:39], v[84:87], v[20:23], v[36:39]
    v_mfma_f32_16x16x32_bf16 v[40:43], v[100:103], v[20:23], v[40:43]
    v_mfma_f32_16x16x32_bf16 v[44:47], v[116:119], v[20:23], v[44:47]
    v_mfma_f32_16x16x32_bf16 v[32:35], v[72:75], v[24:27], v[32:35]
    v_mfma_f32_16x16x32_bf16 v[36:39], v[88:91], v[24:27], v[36:39]
    v_mfma_f32_16x16x32_bf16 v[40:43], v[104:107], v[24:27], v[40:43]
    v_mfma_f32_16x16x32_bf16 v[44:47], v[120:123], v[24:27], v[44:47]
    v_mfma_f32_16x16x32_bf16 v[32:35], v[76:79], v[28:31], v[32:35]
    v_mfma_f32_16x16x32_bf16 v[36:39], v[92:95], v[28:31], v[36:39]
    v_mfma_f32_16x16x32_bf16 v[40:43], v[108:111], v[28:31], v[40:43]
    v_mfma_f32_16x16x32_bf16 v[44:47], v[124:127], v[28:31], v[44:47]
    s_mov_b32 s58, 100000
    s_nop 6
Lsp11:
    ds_read_b32 v9, v8 offset:0
    s_waitcnt lgkmcnt(0)
    v_readfirstlane_b32 s59, v9
    s_nop 0
    s_cmp_ge_u32 s59, 64
    s_nop 2
    s_cbranch_scc1 Lsd12
    s_sleep 1
    s_sub_u32 s58, s58, 1
    s_cbranch_scc0 Lsp11
Lsd12:
    ds_read_b64_tr_b16 v[48:49], v62 offset:0
    ds_read_b64_tr_b16 v[50:51], v62 offset:4096
    ds_read_b64_tr_b16 v[52:53], v63 offset:0
    ds_read_b64_tr_b16 v[54:55], v63 offset:4096
    ds_read_b64_tr_b16 v[56:57], v62 offset:8192
    ds_read_b64_tr_b16 v[58:59], v62 offset:12288
    ds_read_b64_tr_b16 v[60:61], v63 offset:8192
    ds_read_b64_tr_b16 v[62:63], v63 offset:12288
    v_cndmask_b32 v16, v32, v40, vcc
    v_cndmask_b32 v17, v33, v41, vcc
    v_cndmask_b32 v18, v34, v42, vcc
    v_cndmask_b32 v19, v35, v43, vcc
    v_cndmask_b32 v20, v36, v44, vcc
    v_cndmask_b32 v21, v37, v45, vcc
    v_cndmask_b32 v22, v38, v46, vcc
    v_cndmask_b32 v23, v39, v47, vcc
    v_cvt_pk_bf16_f32 v24, v16, v17
    v_cvt_pk_bf16_f32 v25, v18, v19
    v_cvt_pk_bf16_f32 v26, v20, v21
    v_cvt_pk_bf16_f32 v27, v22, v23
    v_lshlrev_b32 v16, 16, v24
    v_and_b32 v17, 0xffff0000, v24
    v_lshlrev_b32 v18, 16, v25
    v_and_b32 v19, 0xffff0000, v25
    v_lshlrev_b32 v20, 16, v26
    v_and_b32 v21, 0xffff0000, v26
    v_lshlrev_b32 v22, 16, v27
    v_and_b32 v23, 0xffff0000, v27
    v_mul_f32 v16, s56, v16
    v_mul_f32 v17, s56, v17
    v_mul_f32 v18, s56, v18
    v_mul_f32 v19, s56, v19
    v_mul_f32 v20, s56, v20
    v_mul_f32 v21, s56, v21
    v_mul_f32 v22, s56, v22
    v_mul_f32 v23, s56, v23
    v_cvt_pk_bf16_f32 v24, v16, v17
    v_cvt_pk_bf16_f32 v25, v18, v19
    v_cvt_pk_bf16_f32 v26, v20, v21
    v_cvt_pk_bf16_f32 v27, v22, v23
    v_lshlrev_b32 v16, 16, v24
    v_and_b32 v17, 0xffff0000, v24
    v_lshlrev_b32 v18, 16, v25
    v_and_b32 v19, 0xffff0000, v25
    v_lshlrev_b32 v20, 16, v26
    v_and_b32 v21, 0xffff0000, v26
    v_lshlrev_b32 v22, 16, v27
    v_and_b32 v23, 0xffff0000, v27
    v_max3_f32 v28, v16, v17, v18
    v_max3_f32 v29, v19, v20, v21
    v_max3_f32 v28, v28, v22, v23
    v_max_f32 v28, v28, v29
    s_nop 1
    v_max_f32_dpp v28, v28, v28 row_ror:8 row_mask:0xf bank_mask:0xf
    v_mov_b32 v29, v28
    s_nop 1
    v_permlane16_swap_b32 v28, v29
    v_max_f32 v28, v28, v29
    v_mov_b32 v29, v28
    s_nop 1
    v_permlane32_swap_b32 v28, v29
    v_max_f32 v28, v28, v29
    v_mul_f32 v28, s57, v28
    v_fma_f32 v16, v16, s57, -v28
    v_fma_f32 v17, v17, s57, -v28
    v_fma_f32 v18, v18, s57, -v28
    v_fma_f32 v19, v19, s57, -v28
    v_fma_f32 v20, v20, s57, -v28
    v_fma_f32 v21, v21, s57, -v28
    v_fma_f32 v22, v22, s57, -v28
    v_fma_f32 v23, v23, s57, -v28
    v_exp_f32 v16, v16
    v_exp_f32 v17, v17
    v_exp_f32 v18, v18
    v_exp_f32 v19, v19
    v_exp_f32 v20, v20
    v_exp_f32 v21, v21
    v_exp_f32 v22, v22
    v_exp_f32 v23, v23
    v_cvt_pk_bf16_f32 v24, v16, v17
    v_cvt_pk_bf16_f32 v25, v18, v19
    v_cvt_pk_bf16_f32 v26, v20, v21
    v_cvt_pk_bf16_f32 v27, v22, v23
    s_waitcnt lgkmcnt(0)
    s_nop 0
    v_mfma_f32_16x16x32_bf16 v[32:35], v[48:51], v[24:27], 0
    v_mfma_f32_16x16x32_bf16 v[36:39], v[52:55], v[24:27], 0
    v_mfma_f32_16x16x32_bf16 v[40:43], v[56:59], v[24:27], 0
    v_mfma_f32_16x16x32_bf16 v[44:47], v[60:63], v[24:27], 0
    ds_bpermute_b32 v64, v7, v28
    v_add_f32 v16, v16, v17
    v_add_f32 v18, v18, v19
    v_add_f32 v20, v20, v21
    v_add_f32 v22, v22, v23
    v_add_f32 v16, v16, v18
    v_add_f32 v20, v20, v22
    v_add_f32 v16, v16, v20
    v_add_f32_dpp v32, v40, v32 row_ror:8 row_mask:0xf bank_mask:0x3
    v_add_f32_dpp v33, v41, v33 row_ror:8 row_mask:0xf bank_mask:0x3
    v_add_f32_dpp v34, v42, v34 row_ror:8 row_mask:0xf bank_mask:0x3
    v_add_f32_dpp v35, v43, v35 row_ror:8 row_mask:0xf bank_mask:0x3
    v_add_f32_dpp v32, v36, v44 row_ror:8 row_mask:0xf bank_mask:0xc
    v_add_f32_dpp v33, v37, v45 row_ror:8 row_mask:0xf bank_mask:0xc
    v_add_f32_dpp v34, v38, v46 row_ror:8 row_mask:0xf bank_mask:0xc
    v_add_f32_dpp v35, v39, v47 row_ror:8 row_mask:0xf bank_mask:0xc
    v_bfi_b32 v32, s49, v32, v10
    v_bfi_b32 v33, s49, v33, v10
    v_bfi_b32 v34, s49, v34, v10
    v_bfi_b32 v35, s49, v35, v10
    buffer_store_dwordx4 v[32:35], v5, s[36:39], 0 offen sc1
    v_add_f32_dpp v16, v16, v16 row_ror:8 row_mask:0xf bank_mask:0xf
    v_mov_b32 v17, v16
    s_nop 1
    v_permlane16_swap_b32 v16, v17
    v_add_f32 v16, v16, v17
    v_mov_b32 v17, v16
    s_nop 1
    v_permlane32_swap_b32 v16, v17
    v_add_f32 v16, v16, v17
    ds_bpermute_b32 v65, v7, v16
    v_mov_b32 v66, s50
    v_mov_b32 v67, s50
    s_lshl_b32 s44, s26, 14
    s_lshl_b32 s45, s31, 12
    s_add_u32 s44, s44, s45
    s_add_u32 s44, s44, 262144
    v_lshl_add_u32 v13, v0, 4, s44
    s_lshr_b32 s44, s26, 1
    s_lshl_b32 s44, s44, 10
    s_add_u32 s44, s44, 1310720
    v_lshl_add_u32 v14, v0, 4, s44
    s_waitcnt lgkmcnt(0)
    s_mov_b64 exec, 0x11
    buffer_store_dwordx4 v[64:67], v6, s[36:39], 0 offen sc1
    s_mov_b64 exec, -1
    s_lshl_b32 s54, s31, 10
    s_add_u32 s44, s54, 126976
    v_lshl_add_u32 v48, v4, 12, v3
    v_add_u32 v48, s44, v48
    v_xor_b32 v49, 32, v48
    v_xor_b32 v50, 64, v48
    v_xor_b32 v51, 0x60, v48
    v_lshl_add_u32 v6, v2, 4, v8
    s_lshl_b32 s47, s27, 17
    s_lshl_b32 s54, s31, 15
    s_add_u32 s47, s47, s54
    s_lshl_b32 s54, s26, 6
    s_add_u32 s47, s47, s54
    s_add_u32 s47, s47, 1572864
    v_lshl_add_u32 v7, v2, 13, s47
    v_lshl_add_u32 v7, v1, 2, v7
    s_mov_b32 s54, 0xffff0000
    s_mov_b32 s55, 0xffff0000
    s_mov_b32 s56, 0
    s_mov_b32 s57, -1
    s_lshr_b32 s44, s31, 1
    s_lshl_b32 s44, s44, 6
    s_and_b32 s45, s31, 1
    s_lshl_b32 s45, s45, 3
    s_add_u32 s44, s44, s45
    v_lshl_add_u32 v15, v12, 4, v8
    v_lshl_add_u32 v15, v2, 1, v15
    v_add_u32 v15, s44, v15
    s_cmp_ge_u32 s2, 224
    s_cselect_b32 s46, 2, 2
    s_mov_b32 s58, 100000
Lsp13:
    ds_read_b32 v9, v8 offset:28
    s_waitcnt lgkmcnt(0)
    v_readfirstlane_b32 s59, v9
    s_nop 0
    s_cmp_ge_u32 s59, s46
    s_nop 2
    s_cbranch_scc1 Lsd14
    s_sleep 1
    s_sub_u32 s58, s58, 1
    s_cbranch_scc0 Lsp13
Lsd14:
    buffer_load_dwordx4 v[32:35], v14, s[36:39], 0 offen sc1
    buffer_load_dwordx4 v[16:19], v13, s[36:39], 0 offen offset:0 sc1
    buffer_load_dwordx4 v[20:23], v13, s[36:39], 0 offen offset:1024 sc1
    buffer_load_dwordx4 v[24:27], v13, s[36:39], 0 offen offset:2048 sc1
    buffer_load_dwordx4 v[28:31], v13, s[36:39], 0 offen offset:3072 sc1
    s_mov_b32 s58, 100000
Lsp15:
    ds_read_b32 v9, v8 offset:0
    s_waitcnt lgkmcnt(0)
    v_readfirstlane_b32 s59, v9
    s_nop 0
    s_cmp_ge_u32 s59, 140
    s_nop 2
    s_cbranch_scc1 Lsd16
    s_sleep 1
    s_sub_u32 s58, s58, 1
    s_cbranch_scc0 Lsp15
Lsd16:
    ds_read_b64_tr_b16 v[64:65], v48 offset:0
    ds_read_b64_tr_b16 v[66:67], v48 offset:8192
    ds_read_b64_tr_b16 v[68:69], v49 offset:0
    ds_read_b64_tr_b16 v[70:71], v49 offset:8192
    ds_read_b64_tr_b16 v[72:73], v50 offset:0
    ds_read_b64_tr_b16 v[74:75], v50 offset:8192
    ds_read_b64_tr_b16 v[76:77], v51 offset:0
    ds_read_b64_tr_b16 v[78:79], v51 offset:8192
    s_waitcnt vmcnt(0)
    ds_read_b32 v9, v8 offset:0
    ds_read_b64_tr_b16 v[80:81], v48 offset:16384
    ds_read_b64_tr_b16 v[82:83], v48 offset:24576
    ds_read_b64_tr_b16 v[84:85], v49 offset:16384
    ds_read_b64_tr_b16 v[86:87], v49 offset:24576
    ds_read_b64_tr_b16 v[88:89], v50 offset:16384
    ds_read_b64_tr_b16 v[90:91], v50 offset:24576
    ds_read_b64_tr_b16 v[92:93], v51 offset:16384
    ds_read_b64_tr_b16 v[94:95], v51 offset:24576
    v_mov_b32 v36, v32
    v_bitop3_b32 v40, v16, v17, s48 bitop3:0x7e
    v_bitop3_b32 v41, v18, v19, s48 bitop3:0x7e
    v_max_f32_dpp v36, v36, v36 row_ror:8 row_mask:0xf bank_mask:0xf
    v_bitop3_b32 v42, v20, v21, s48 bitop3:0x7e
    v_or3_b32 v40, v40, v41, v42
    v_max_f32_dpp v36, v36, v36 row_ror:4 row_mask:0xf bank_mask:0xf
    v_bitop3_b32 v41, v22, v23, s48 bitop3:0x7e
    v_bitop3_b32 v42, v24, v25, s48 bitop3:0x7e
    v_max_f32_dpp v36, v36, v36 row_ror:2 row_mask:0xf bank_mask:0xf
    v_or3_b32 v40, v40, v41, v42
    v_bitop3_b32 v41, v26, v27, s48 bitop3:0x7e
    v_max_f32_dpp v36, v36, v36 row_ror:1 row_mask:0xf bank_mask:0xf
    v_bitop3_b32 v42, v28, v29, s48 bitop3:0x7e
    v_or3_b32 v40, v40, v41, v42
    v_mov_b32 v37, v36
    v_bitop3_b32 v41, v30, v31, s48 bitop3:0x7e
    v_or_b32 v40, v40, v41
    v_permlane16_swap_b32 v36, v37
    v_and_b32 v40, 0xff, v40
    v_xor_b32 v41, s50, v34
    v_max_f32 v36, v36, v37
    v_or_b32 v42, v40, v41
    v_cmp_ne_u32 vcc, 0, v42
    v_mov_b32 v37, v36
    s_nop 1
    v_permlane32_swap_b32 v36, v37
    v_max_f32 v36, v36, v37
    s_nop 1
    s_cbranch_vccz Logo
    s_mov_b32 s58, 100000
Lcmb:
    s_sleep 2
    v_cmp_ne_u32 vcc, 0, v41
    s_nop 0
    s_mov_b64 exec, vcc
    buffer_load_dwordx4 v[32:35], v14, s[36:39], 0 offen sc1
    s_mov_b64 exec, -1
    v_cmp_ne_u32 vcc, 0, v40
    s_nop 0
    s_mov_b64 exec, vcc
    buffer_load_dwordx4 v[16:19], v13, s[36:39], 0 offen offset:0 sc1
    buffer_load_dwordx4 v[20:23], v13, s[36:39], 0 offen offset:1024 sc1
    buffer_load_dwordx4 v[24:27], v13, s[36:39], 0 offen offset:2048 sc1
    buffer_load_dwordx4 v[28:31], v13, s[36:39], 0 offen offset:3072 sc1
    s_mov_b64 exec, -1
    s_waitcnt vmcnt(0)
    v_bitop3_b32 v40, v16, v17, s48 bitop3:0x7e
    v_bitop3_b32 v41, v18, v19, s48 bitop3:0x7e
    v_bitop3_b32 v42, v20, v21, s48 bitop3:0x7e
    v_or3_b32 v40, v40, v41, v42
    v_bitop3_b32 v41, v22, v23, s48 bitop3:0x7e
    v_bitop3_b32 v42, v24, v25, s48 bitop3:0x7e
    v_or3_b32 v40, v40, v41, v42
    v_bitop3_b32 v41, v26, v27, s48 bitop3:0x7e
    v_bitop3_b32 v42, v28, v29, s48 bitop3:0x7e
    v_or3_b32 v40, v40, v41, v42
    v_bitop3_b32 v41, v30, v31, s48 bitop3:0x7e
    v_or_b32 v40, v40, v41
    v_and_b32 v40, 0xff, v40
    v_xor_b32 v41, s50, v34
    v_or_b32 v42, v40, v41
    v_cmp_ne_u32 vcc, 0, v42
    s_nop 4
    s_cbranch_vccz Lcmbd
    s_sub_u32 s58, s58, 1
    s_cbranch_scc0 Lcmb
Lcmbd:
    v_mov_b32 v36, v32
    s_nop 1
    v_max_f32_dpp v36, v36, v36 row_ror:8 row_mask:0xf bank_mask:0xf
    s_nop 1
    v_max_f32_dpp v36, v36, v36 row_ror:4 row_mask:0xf bank_mask:0xf
    s_nop 1
    v_max_f32_dpp v36, v36, v36 row_ror:2 row_mask:0xf bank_mask:0xf
    s_nop 1
    v_max_f32_dpp v36, v36, v36 row_ror:1 row_mask:0xf bank_mask:0xf
    v_mov_b32 v37, v36
    s_nop 1
    v_permlane16_swap_b32 v36, v37
    v_max_f32 v36, v36, v37
    v_mov_b32 v37, v36
    s_nop 1
    v_permlane32_swap_b32 v36, v37
    v_max_f32 v36, v36, v37
    s_nop 1
Logo:
    v_sub_f32 v32, v32, v36
    v_exp_f32 v32, v32
    s_nop 0
    v_mul_f32 v33, v32, v33
    v_mul_f32_dpp v36, v32, v16 quad_perm:[0,0,0,0] row_mask:0xf bank_mask:0xf
    v_mul_f32_dpp v37, v32, v17 quad_perm:[0,0,0,0] row_mask:0xf bank_mask:0xf
    v_add_f32_dpp v33, v33, v33 row_ror:8 row_mask:0xf bank_mask:0xf
    v_mul_f32_dpp v38, v32, v18 quad_perm:[0,0,0,0] row_mask:0xf bank_mask:0xf
    v_mul_f32_dpp v39, v32, v19 quad_perm:[0,0,0,0] row_mask:0xf bank_mask:0xf
    v_add_f32_dpp v33, v33, v33 row_ror:4 row_mask:0xf bank_mask:0xf
    v_fmac_f32_dpp v36, v32, v20 quad_perm:[1,1,1,1] row_mask:0xf bank_mask:0xf
    v_fmac_f32_dpp v37, v32, v21 quad_perm:[1,1,1,1] row_mask:0xf bank_mask:0xf
    v_add_f32_dpp v33, v33, v33 row_ror:2 row_mask:0xf bank_mask:0xf
    v_fmac_f32_dpp v38, v32, v22 quad_perm:[1,1,1,1] row_mask:0xf bank_mask:0xf
    v_fmac_f32_dpp v39, v32, v23 quad_perm:[1,1,1,1] row_mask:0xf bank_mask:0xf
    v_add_f32_dpp v33, v33, v33 row_ror:1 row_mask:0xf bank_mask:0xf
    v_fmac_f32_dpp v36, v32, v24 quad_perm:[2,2,2,2] row_mask:0xf bank_mask:0xf
    v_fmac_f32_dpp v37, v32, v25 quad_perm:[2,2,2,2] row_mask:0xf bank_mask:0xf
    v_mov_b32 v40, v33
    v_fmac_f32_dpp v38, v32, v26 quad_perm:[2,2,2,2] row_mask:0xf bank_mask:0xf
    v_fmac_f32_dpp v39, v32, v27 quad_perm:[2,2,2,2] row_mask:0xf bank_mask:0xf
    v_permlane16_swap_b32 v33, v40
    v_fmac_f32_dpp v36, v32, v28 quad_perm:[3,3,3,3] row_mask:0xf bank_mask:0xf
    v_fmac_f32_dpp v37, v32, v29 quad_perm:[3,3,3,3] row_mask:0xf bank_mask:0xf
    v_add_f32 v33, v33, v40
    v_fmac_f32_dpp v38, v32, v30 quad_perm:[3,3,3,3] row_mask:0xf bank_mask:0xf
    v_fmac_f32_dpp v39, v32, v31 quad_perm:[3,3,3,3] row_mask:0xf bank_mask:0xf
    v_mov_b32 v40, v33
    v_permlane32_swap_b32 v36, v38
    v_permlane32_swap_b32 v37, v39
    v_permlane32_swap_b32 v33, v40
    v_add_f32 v36, v36, v38
    v_add_f32 v37, v37, v39
    v_add_f32 v33, v33, v40
    v_rcp_f32 v33, v33
    v_permlane16_swap_b32 v36, v37
    v_add_f32 v36, v36, v37
    s_waitcnt lgkmcnt(0)
    v_readfirstlane_b32 s59, v9
    v_add_f32_dpp v36, v36, v36 row_ror:8 row_mask:0xf bank_mask:0xf
    s_nop 1
    v_add_f32_dpp v36, v36, v36 row_ror:4 row_mask:0xf bank_mask:0xf
    v_mul_f32 v36, v36, v33
    v_cvt_pk_bf16_f32 v36, v36, v36
    ds_write_b16 v15, v36 offset:576
    s_mov_b64 exec, 1
    ds_add_u32 v8, v11 offset:12
    s_mov_b64 exec, -1
    s_cmp_ge_u32 s59, 156
    s_cbranch_scc1 Lwok
    s_mov_b32 s58, 100000
Lsp17:
    ds_read_b32 v9, v8 offset:0
    s_waitcnt lgkmcnt(0)
    v_readfirstlane_b32 s59, v9
    s_nop 0
    s_cmp_ge_u32 s59, 156
    s_nop 2
    s_cbranch_scc1 Lsd18
    s_sub_u32 s58, s58, 1
    s_cbranch_scc0 Lsp17
Lsd18:
    ds_read_b64_tr_b16 v[80:81], v48 offset:16384
    ds_read_b64_tr_b16 v[82:83], v48 offset:24576
    ds_read_b64_tr_b16 v[84:85], v49 offset:16384
    ds_read_b64_tr_b16 v[86:87], v49 offset:24576
    ds_read_b64_tr_b16 v[88:89], v50 offset:16384
    ds_read_b64_tr_b16 v[90:91], v50 offset:24576
    ds_read_b64_tr_b16 v[92:93], v51 offset:16384
    ds_read_b64_tr_b16 v[94:95], v51 offset:24576
Lwok:
    s_mov_b32 s58, 100000
Lsp19:
    ds_read_b32 v9, v8 offset:12
    ds_read_b128 v[16:19], v6 offset:576
    ds_read_b128 v[20:23], v6 offset:640
    s_waitcnt lgkmcnt(0)
    v_readfirstlane_b32 s59, v9
    s_nop 0
    s_cmp_ge_u32 s59, 4
    s_nop 2
    s_cbranch_scc1 Lsd20
    s_sub_u32 s58, s58, 1
    s_cbranch_scc0 Lsp19
Lsd20:
    v_mfma_f32_16x16x32_bf16 v[96:99], v[16:19], v[64:67], 0
    v_mfma_f32_16x16x32_bf16 v[100:103], v[16:19], v[68:71], 0
    v_mfma_f32_16x16x32_bf16 v[104:107], v[16:19], v[72:75], 0
    v_mfma_f32_16x16x32_bf16 v[108:111], v[16:19], v[76:79], 0
    v_mfma_f32_16x16x32_bf16 v[96:99], v[20:23], v[80:83], v[96:99]
    v_mfma_f32_16x16x32_bf16 v[100:103], v[20:23], v[84:87], v[100:103]
    v_mfma_f32_16x16x32_bf16 v[104:107], v[20:23], v[88:91], v[104:107]
    v_mfma_f32_16x16x32_bf16 v[108:111], v[20:23], v[92:95], v[108:111]
    s_nop 5
    v_cndmask_b32 v96, v96, v100, s[54:55]
    s_nop 0
    v_cndmask_b32 v104, v104, v108, s[54:55]
    v_cndmask_b32 v96, v96, v104, s[56:57]
    v_bfi_b32 v96, s49, v96, v10
    buffer_store_dword v96, v7, s[36:39], 0 offen sc1
    s_mov_b64 exec, 1
    ds_add_u32 v8, v11 offset:20
    s_mov_b64 exec, -1
    s_branch Lfin
Lmlp:
    s_lshl_b32 s54, s31, 10
    s_add_u32 s44, s54, 0
    v_lshl_add_u32 v48, v4, 12, v3
    v_add_u32 v48, s44, v48
    v_xor_b32 v49, 32, v48
    v_xor_b32 v50, 64, v48
    v_xor_b32 v51, 0x60, v48
    v_lshl_add_u32 v6, v2, 4, v8
    s_lshl_b32 s47, s27, 17
    s_lshl_b32 s54, s31, 15
    s_add_u32 s47, s47, s54
    s_lshl_b32 s54, s26, 6
    s_add_u32 s47, s47, s54
    s_add_u32 s47, s47, 1576960
    v_lshl_add_u32 v7, v2, 13, s47
    v_lshl_add_u32 v7, v1, 2, v7
    s_mov_b32 s54, 0xffff0000
    s_mov_b32 s55, 0xffff0000
    s_mov_b32 s56, 0
    s_mov_b32 s57, -1
    s_cmp_eq_u32 s3, 5
    s_cbranch_scc1 Lmlp1
    s_mov_b32 s58, 100000
Lsp21:
    ds_read_b32 v9, v8 offset:0
    s_waitcnt lgkmcnt(0)
    v_readfirstlane_b32 s59, v9
    s_nop 0
    s_cmp_ge_u32 s59, 124
    s_nop 2
    s_cbranch_scc1 Lsd22
    s_sleep 1
    s_sub_u32 s58, s58, 1
    s_cbranch_scc0 Lsp21
Lsd22:
    ds_read_b64_tr_b16 v[64:65], v48 offset:0
    ds_read_b64_tr_b16 v[66:67], v48 offset:8192
    ds_read_b64_tr_b16 v[68:69], v49 offset:0
    ds_read_b64_tr_b16 v[70:71], v49 offset:8192
    ds_read_b64_tr_b16 v[72:73], v50 offset:0
    ds_read_b64_tr_b16 v[74:75], v50 offset:8192
    ds_read_b64_tr_b16 v[76:77], v51 offset:0
    ds_read_b64_tr_b16 v[78:79], v51 offset:8192
    ds_read_b64_tr_b16 v[80:81], v48 offset:16384
    ds_read_b64_tr_b16 v[82:83], v48 offset:24576
    ds_read_b64_tr_b16 v[84:85], v49 offset:16384
    ds_read_b64_tr_b16 v[86:87], v49 offset:24576
    ds_read_b64_tr_b16 v[88:89], v50 offset:16384
    ds_read_b64_tr_b16 v[90:91], v50 offset:24576
    ds_read_b64_tr_b16 v[92:93], v51 offset:16384
    ds_read_b64_tr_b16 v[94:95], v51 offset:24576
    s_branch Lmlp2
Lmlp1:
    s_mul_i32 s44, s26, 224
    s_add_u32 s44, s44, 69632
    v_min_u32 v5, 13, v1
    v_lshl_add_u32 v5, v5, 4, s44
    v_lshl_add_u32 v5, v2, 14, v5
    v_lshrrev_b32 v24, 3, v1
    v_lshl_add_u32 v24, v24, 6, v8
    v_and_b32 v25, 3, v1
    v_lshl_add_u32 v24, v25, 4, v24
    v_bfe_u32 v25, v1, 2, 1
    v_lshl_add_u32 v24, v25, 3, v24
    v_lshl_add_u32 v24, v2, 1, v24
    v_cmp_gt_u32 s[52:53], 14, v1
    v_mov_b32 v25, 4
    s_cmp_ge_u32 s2, 224
    s_cselect_b32 s46, 1, 1
    s_mov_b32 s58, 100000
    s_nop 0
Lsp23:
    ds_read_b32 v9, v8 offset:28
    s_waitcnt lgkmcnt(0)
    v_readfirstlane_b32 s59, v9
    s_nop 0
    s_cmp_ge_u32 s59, s46
    s_nop 2
    s_cbranch_scc1 Lsd24
    s_sleep 1
    s_sub_u32 s58, s58, 1
    s_cbranch_scc0 Lsp23
Lsd24:
    buffer_load_dwordx4 v[12:15], v5, s[36:39], 0 offen sc1
    s_mov_b32 s58, 100000
Lsp27:
    ds_read_b32 v9, v8 offset:0
    s_waitcnt lgkmcnt(0)
    v_readfirstlane_b32 s59, v9
    s_nop 0
    s_cmp_ge_u32 s59, 124
    s_nop 2
    s_cbranch_scc1 Lsd28
    s_sleep 1
    s_sub_u32 s58, s58, 1
    s_cbranch_scc0 Lsp27
Lsd28:
    ds_read_b64_tr_b16 v[64:65], v48 offset:0
    ds_read_b64_tr_b16 v[66:67], v48 offset:8192
    ds_read_b64_tr_b16 v[68:69], v49 offset:0
    ds_read_b64_tr_b16 v[70:71], v49 offset:8192
    ds_read_b64_tr_b16 v[72:73], v50 offset:0
    ds_read_b64_tr_b16 v[74:75], v50 offset:8192
    ds_read_b64_tr_b16 v[76:77], v51 offset:0
    ds_read_b64_tr_b16 v[78:79], v51 offset:8192
    ds_read_b64_tr_b16 v[80:81], v48 offset:16384
    ds_read_b64_tr_b16 v[82:83], v48 offset:24576
    ds_read_b64_tr_b16 v[84:85], v49 offset:16384
    ds_read_b64_tr_b16 v[86:87], v49 offset:24576
    ds_read_b64_tr_b16 v[88:89], v50 offset:16384
    ds_read_b64_tr_b16 v[90:91], v50 offset:24576
    ds_read_b64_tr_b16 v[92:93], v51 offset:16384
    ds_read_b64_tr_b16 v[94:95], v51 offset:24576
    s_mov_b32 s58, 100000
Lpl25:
    s_waitcnt vmcnt(0)
    v_bitop3_b32 v16, v12, v13, s48 bitop3:0x7e
    v_bitop3_b32 v17, v14, v15, s48 bitop3:0x7e
    v_or_b32 v16, v16, v17
    v_and_b32 v16, 0xff, v16
    v_cmp_ne_u32 vcc, 0, v16
    s_nop 4
    s_cbranch_vccz Lpd26
    s_sleep 16
    s_mov_b64 exec, vcc
    buffer_load_dwordx4 v[12:15], v5, s[36:39], 0 offen sc1
    s_mov_b64 exec, -1
    s_sub_u32 s58, s58, 1
    s_cbranch_scc0 Lpl25
Lpd26:
    v_permlane32_swap_b32 v12, v14
    v_permlane32_swap_b32 v13, v15
    v_add_f32 v12, v12, v14
    v_add_f32 v13, v13, v15
    s_nop 1
    v_permlane16_swap_b32 v12, v13
    v_add_f32 v12, v12, v13
    v_cvt_pk_bf16_f32 v12, v12, v12
    v_lshlrev_b32 v12, 16, v12
    v_mul_f32 v16, 0xbfb8aa3b, v12
    v_exp_f32 v16, v16
    s_nop 0
    v_add_f32 v16, 1.0, v16
    v_rcp_f32 v16, v16
    s_nop 0
    v_mul_f32 v12, v12, v16
    v_cvt_pk_bf16_f32 v12, v12, v12
    v_cndmask_b32 v12, 0, v12, s[52:53]
    ds_write_b16 v24, v12 offset:704
    ds_write_b32 v8, v25 offset:16
Lmlp2:
    s_mov_b32 s58, 100000
Lsp29:
    ds_read_b32 v9, v8 offset:16
    ds_read_b128 v[16:19], v6 offset:704
    ds_read_b128 v[20:23], v6 offset:768
    s_waitcnt lgkmcnt(0)
    v_readfirstlane_b32 s59, v9
    s_nop 0
    s_cmp_ge_u32 s59, 4
    s_nop 2
    s_cbranch_scc1 Lsd30
    s_sleep 1
    s_sub_u32 s58, s58, 1
    s_cbranch_scc0 Lsp29
Lsd30:
    v_mfma_f32_16x16x32_bf16 v[96:99], v[16:19], v[64:67], 0
    v_mfma_f32_16x16x32_bf16 v[100:103], v[16:19], v[68:71], 0
    v_mfma_f32_16x16x32_bf16 v[104:107], v[16:19], v[72:75], 0
    v_mfma_f32_16x16x32_bf16 v[108:111], v[16:19], v[76:79], 0
    v_mfma_f32_16x16x32_bf16 v[96:99], v[20:23], v[80:83], v[96:99]
    v_mfma_f32_16x16x32_bf16 v[100:103], v[20:23], v[84:87], v[100:103]
    v_mfma_f32_16x16x32_bf16 v[104:107], v[20:23], v[88:91], v[104:107]
    v_mfma_f32_16x16x32_bf16 v[108:111], v[20:23], v[92:95], v[108:111]
    s_nop 5
    v_cndmask_b32 v96, v96, v100, s[54:55]
    s_nop 0
    v_cndmask_b32 v104, v104, v108, s[54:55]
    v_cndmask_b32 v96, v96, v104, s[56:57]
    v_bfi_b32 v96, s49, v96, v10
    buffer_store_dword v96, v7, s[36:39], 0 offen sc1
    s_cmp_eq_u32 s3, 5
    s_cbranch_scc0 Lfin
    s_cmp_eq_u32 s27, 0
    s_cbranch_scc0 Lfin
    s_lshl_b32 s44, s26, 13
    s_add_u32 s44, s44, 1572864
    v_lshl_add_u32 v5, v0, 4, s44
    s_movk_i32 s45, 4096
    s_mov_b32 s40, s24
    s_and_b32 s41, s25, 0xffff
    s_mov_b32 s42, 2048
    s_mov_b32 s43, 0x20000
    ds_read_b32 v9, v8 offset:24
    s_waitcnt lgkmcnt(0)
    v_readfirstlane_b32 s59, v9
    s_nop 0
    s_cmp_ge_u32 s59, 4
    s_nop 2
    s_cbranch_scc1 Lnw
    s_mov_b32 s58, 100000
Lsp31:
    ds_read_b32 v9, v8 offset:20
    s_waitcnt lgkmcnt(0)
    v_readfirstlane_b32 s59, v9
    s_nop 0
    s_cmp_ge_u32 s59, 4
    s_nop 2
    s_cbranch_scc1 Lsd32
    s_sleep 1
    s_sub_u32 s58, s58, 1
    s_cbranch_scc0 Lsp31
Lsd32:
Lnw:
    buffer_load_dwordx4 v[32:35], v5, s[36:39], s45 offen offset:0 sc1
    buffer_load_dwordx4 v[36:39], v5, s[36:39], s45 offen offset:1024 sc1
    buffer_load_dwordx4 v[40:43], v5, s[36:39], s45 offen offset:2048 sc1
    buffer_load_dwordx4 v[44:47], v5, s[36:39], s45 offen offset:3072 sc1
    s_mov_b32 s58, 100000
Lpl33:
    s_waitcnt vmcnt(0)
    v_bitop3_b32 v12, v32, v33, s48 bitop3:0x7e
    v_bitop3_b32 v13, v34, v35, s48 bitop3:0x7e
    v_bitop3_b32 v14, v36, v37, s48 bitop3:0x7e
    v_or3_b32 v12, v12, v13, v14
    v_bitop3_b32 v13, v38, v39, s48 bitop3:0x7e
    v_bitop3_b32 v14, v40, v41, s48 bitop3:0x7e
    v_or3_b32 v12, v12, v13, v14
    v_bitop3_b32 v13, v42, v43, s48 bitop3:0x7e
    v_bitop3_b32 v14, v44, v45, s48 bitop3:0x7e
    v_or3_b32 v12, v12, v13, v14
    v_bitop3_b32 v13, v46, v47, s48 bitop3:0x7e
    v_or_b32 v12, v12, v13
    v_and_b32 v12, 0xff, v12
    v_cmp_ne_u32 vcc, 0, v12
    s_nop 4
    s_cbranch_vccz Lpd34
    s_sleep 2
    s_mov_b64 exec, vcc
    buffer_load_dwordx4 v[32:35], v5, s[36:39], s45 offen offset:0 sc1
    buffer_load_dwordx4 v[36:39], v5, s[36:39], s45 offen offset:1024 sc1
    buffer_load_dwordx4 v[40:43], v5, s[36:39], s45 offen offset:2048 sc1
    buffer_load_dwordx4 v[44:47], v5, s[36:39], s45 offen offset:3072 sc1
    s_mov_b64 exec, -1
    s_sub_u32 s58, s58, 1
    s_cbranch_scc0 Lpl33
Lpd34:
    v_add_f32 v32, v32, v36
    v_add_f32 v40, v40, v44
    v_add_f32 v33, v33, v37
    v_add_f32 v41, v41, v45
    v_add_f32 v34, v34, v38
    v_add_f32 v42, v42, v46
    v_add_f32 v35, v35, v39
    v_add_f32 v43, v43, v47
    v_add_f32 v32, v32, v40
    v_add_f32 v33, v33, v41
    v_add_f32 v34, v34, v42
    v_add_f32 v35, v35, v43
    buffer_load_dwordx4 v[16:19], v5, s[36:39], 0 offen offset:0 sc1
    buffer_load_dwordx4 v[20:23], v5, s[36:39], 0 offen offset:1024 sc1
    buffer_load_dwordx4 v[24:27], v5, s[36:39], 0 offen offset:2048 sc1
    buffer_load_dwordx4 v[28:31], v5, s[36:39], 0 offen offset:3072 sc1
    s_mov_b32 s58, 100000
Lpl35:
    s_waitcnt vmcnt(0)
    v_bitop3_b32 v12, v16, v17, s48 bitop3:0x7e
    v_bitop3_b32 v13, v18, v19, s48 bitop3:0x7e
    v_bitop3_b32 v14, v20, v21, s48 bitop3:0x7e
    v_or3_b32 v12, v12, v13, v14
    v_bitop3_b32 v13, v22, v23, s48 bitop3:0x7e
    v_bitop3_b32 v14, v24, v25, s48 bitop3:0x7e
    v_or3_b32 v12, v12, v13, v14
    v_bitop3_b32 v13, v26, v27, s48 bitop3:0x7e
    v_bitop3_b32 v14, v28, v29, s48 bitop3:0x7e
    v_or3_b32 v12, v12, v13, v14
    v_bitop3_b32 v13, v30, v31, s48 bitop3:0x7e
    v_or_b32 v12, v12, v13
    v_and_b32 v12, 0xff, v12
    v_cmp_ne_u32 vcc, 0, v12
    s_nop 4
    s_cbranch_vccz Lpd36
    s_sleep 2
    s_mov_b64 exec, vcc
    buffer_load_dwordx4 v[16:19], v5, s[36:39], 0 offen offset:0 sc1
    buffer_load_dwordx4 v[20:23], v5, s[36:39], 0 offen offset:1024 sc1
    buffer_load_dwordx4 v[24:27], v5, s[36:39], 0 offen offset:2048 sc1
    buffer_load_dwordx4 v[28:31], v5, s[36:39], 0 offen offset:3072 sc1
    s_mov_b64 exec, -1
    s_sub_u32 s58, s58, 1
    s_cbranch_scc0 Lpl35
Lpd36:
    v_add_f32 v16, v16, v20
    v_add_f32 v24, v24, v28
    v_add_f32 v17, v17, v21
    v_add_f32 v25, v25, v29
    v_add_f32 v18, v18, v22
    v_add_f32 v26, v26, v30
    v_add_f32 v19, v19, v23
    v_add_f32 v27, v27, v31
    v_add_f32 v16, v16, v24
    v_add_f32 v17, v17, v25
    v_add_f32 v18, v18, v26
    v_add_f32 v19, v19, v27
    v_permlane32_swap_b32 v16, v32
    v_permlane32_swap_b32 v17, v33
    v_permlane32_swap_b32 v18, v34
    v_permlane32_swap_b32 v19, v35
    v_add_f32 v16, v16, v32
    v_add_f32 v17, v17, v33
    v_add_f32 v18, v18, v34
    v_add_f32 v19, v19, v35
    s_nop 0
    v_permlane16_swap_b32 v16, v18
    v_permlane16_swap_b32 v17, v19
    v_add_f32 v16, v16, v18
    v_add_f32 v17, v17, v19
    s_nop 0
    v_add_f32_dpp v16, v16, v16 row_ror:8 row_mask:0xf bank_mask:0xf
    v_add_f32_dpp v17, v17, v17 row_ror:8 row_mask:0xf bank_mask:0xf
    s_nop 0
    v_add_f32_dpp v16, v16, v16 row_ror:4 row_mask:0xf bank_mask:0xf
    v_add_f32_dpp v17, v17, v17 row_ror:4 row_mask:0xf bank_mask:0xf
    v_cvt_pk_bf16_f32 v16, v16, v17
    v_mov_b32 v17, v16
    s_nop 1
    v_permlane32_swap_b32 v16, v17
    v_lshlrev_b32 v22, 16, v127
    v_and_b32 v23, 0xffff0000, v127
    v_lshlrev_b32 v18, 16, v16
    v_and_b32 v19, 0xffff0000, v16
    v_add_f32 v18, v18, v22
    v_add_f32 v19, v19, v23
    v_cvt_pk_bf16_f32 v16, v18, v19
    v_lshlrev_b32 v18, 16, v16
    v_and_b32 v19, 0xffff0000, v16
    v_lshlrev_b32 v20, 16, v17
    v_and_b32 v21, 0xffff0000, v17
    v_add_f32 v18, v18, v20
    v_add_f32 v19, v19, v21
    v_cvt_pk_bf16_f32 v16, v18, v19
    s_mov_b64 exec, 0xf000f
    buffer_store_dword v16, v126, s[40:43], 0 offen
    s_cmp_eq_u32 s2, 0
    s_cbranch_scc0 Lfin
    s_mov_b64 exec, 1
    buffer_store_dword v10, v126, s[36:39], 0 offen
Lfin:
Lend:
    s_endpgm
.section .rodata,"a"
.p2align 6
.amdhsa_kernel parallel_sum__sliding_block_cached__dense_activation_silu__decode_kernel
  .amdhsa_next_free_vgpr 128
  .amdhsa_next_free_sgpr 102
  .amdhsa_accum_offset 128
  .amdhsa_group_segment_fixed_size 0
  .amdhsa_kernarg_size 88
  .amdhsa_user_sgpr_count 2
  .amdhsa_user_sgpr_kernarg_segment_ptr 1
  .amdhsa_system_sgpr_workgroup_id_x 1
.end_amdhsa_kernel
```
